```python
import torch

def _softmax(x, axis=-1):
    return torch.softmax(x, dim=axis)
def _gelu(x):
    return torch.nn.functional.gelu(x, approximate="tanh")
def _silu(x):
    return torch.nn.functional.silu(x)
def _sigmoid(x):
    return torch.sigmoid(x)
def _layernorm(x, axis=-1, eps=1e-5):
    m = x.mean(dim=axis, keepdim=True)
    v = x.var(dim=axis, keepdim=True, unbiased=False)
    return (x - m) / torch.sqrt(v + eps)
def _scatter_add(tgt, idx, src, axis=0):
    return tgt.clone().index_add_(axis, idx, src)
def _segment_sum(src, seg, n):
    out = torch.zeros((n,) + src.shape[1:], dtype=src.dtype)
    return out.index_add_(0, seg, src)
def _pad(x, pw):
    flat = tuple(v for pair in reversed(pw) for v in pair)
    return torch.nn.functional.pad(x, flat)

kernel_name = 'standalone__dense_activation_silu__prompt'

def setup_inputs():

    _w = (lambda a: (lambda t: t.to(torch.bfloat16) if t.is_floating_point() else t)(torch.as_tensor(a)))
    B, S, D, F = 1, 2048, 576, 4608
    return {
        "x": _w((lambda *s: torch.randn(*s, dtype=torch.bfloat16) * 0.1)(B, S, D)),
        "w1": _w((lambda *s: torch.randn(*s, dtype=torch.bfloat16) * 3.2)(D, F) * (D ** -0.5)),
        "w2": _w((lambda *s: torch.randn(*s, dtype=torch.bfloat16) * 3.2)(F, D) * (F ** -0.5)),
    }

def reference(x, w1, w2):
    h = torch.einsum("bsd,df->bsf", x, w1)
    h = _silu(h)
    out = torch.einsum("bsf,fd->bsd", h, w2)
    return out
```

```asm
; @launch grid=(256,1,1) block=(512,1,1) lds=147520
.amdgcn_target "amdgcn-amd-amdhsa--gfx950"
.text
.globl standalone__dense_activation_silu__prompt_kernel
.p2align 8
.type standalone__dense_activation_silu__prompt_kernel,@function
standalone__dense_activation_silu__prompt_kernel:
    s_cmp_ge_u32 s2, 256
    s_cbranch_scc1 L_end
    s_load_dwordx4 s[80:83], s[0:1], 0
    s_load_dwordx4 s[84:87], s[0:1], 16
    s_load_dwordx4 s[88:91], s[0:1], 32
    s_memrealtime s[92:93]
    v_and_b32 v243, 63, v0
    v_lshrrev_b32 v248, 6, v0
    s_nop 0
    v_readfirstlane_b32 s32, v248
    s_and_b32 s38, s2, 7
    s_lshr_b32 s39, s2, 3
    s_lshr_b32 s29, s38, 1
    s_and_b32 s40, s38, 1
    s_lshl_b32 s40, s40, 3
    s_lshr_b32 s41, s39, 2
    s_add_u32 s28, s40, s41
    s_and_b32 s30, s39, 3
    s_lshl_b32 s31, s29, 2
    s_add_u32 s31, s31, s30
    s_and_b32 s33, s32, 3
    s_lshr_b32 s34, s32, 2
    s_mul_i32 s38, s31, 576
    s_and_b32 s39, s31, 1
    s_lshl_b32 s40, s39, 6
    s_add_u32 s36, s38, s40
    s_xor_b32 s39, s39, 1
    s_lshl_b32 s39, s39, 9
    s_add_u32 s50, s38, s39
    s_mul_i32 s37, s28, 147456
    s_mov_b32 s51, 0xbfb8aa3b
    v_lshrrev_b32 v248, 3, v243
    v_mul_u32_u24 v240, 1152, v248
    v_and_b32 v249, 7, v243
    v_lshrrev_b32 v250, 4, v243
    v_xor_b32 v249, v249, v250
    s_and_b32 s38, s32, 1
    s_lshl_b32 s38, s38, 2
    v_xor_b32 v249, s38, v249
    v_lshlrev_b32 v249, 4, v249
    v_add_u32 v240, v240, v249
    v_lshrrev_b32 v248, 4, v243
    v_mul_u32_u24 v241, 9216, v248
    v_bfe_u32 v249, v243, 2, 2
    v_xor_b32 v249, v249, v248
    v_lshlrev_b32 v249, 6, v249
    v_and_b32 v250, 3, v243
    v_lshlrev_b32 v250, 4, v250
    v_add3_u32 v241, v241, v249, v250
    s_mul_i32 s42, s32, 9216
    s_add_u32 s42, s42, s37
    s_mul_i32 s43, s32, 36864
    s_add_u32 s43, s43, s36
    s_lshl_b32 s62, s32, 10
    s_waitcnt lgkmcnt(0)
    s_mov_b32 s4, s80
    s_mov_b32 s5, s81
    s_mov_b32 s6, 2359296
    s_mov_b32 s7, 0x20000
    s_mov_b32 s8, s82
    s_mov_b32 s9, s83
    s_mov_b32 s10, 5308416
    s_mov_b32 s11, 0x20000
    s_mov_b32 s12, s84
    s_mov_b32 s13, s85
    s_mov_b32 s14, 5308416
    s_mov_b32 s15, 0x20000
    s_mov_b32 s16, s86
    s_mov_b32 s17, s87
    s_mov_b32 s18, 2359296
    s_mov_b32 s19, 0x20000
    s_mov_b32 s24, s88
    s_mov_b32 s25, s89
    s_mov_b32 s26, 256
    s_mov_b32 s27, 0x20000
    s_mov_b32 s20, s90
    s_mov_b32 s21, s91
    s_mov_b32 s22, 268435456
    s_mov_b32 s23, 0x20000
    s_lshl_b32 s38, s28, 2
    v_mov_b32 v254, s38
    s_lshl_b32 s39, s31, 3
    s_add_u32 s39, s39, s32
    s_cmp_lg_u32 s39, 4
    s_cbranch_scc1 L_no_nonce
    s_or_b32 s57, s92, 1
    v_mov_b32 v252, s57
    buffer_store_dword v252, v254, s[24:27], 0 offen sc1
L_no_nonce:
    s_add_u32 m0, s62, 0
    s_add_u32 s39, s42, 0
    buffer_load_dwordx4 v240, s[4:7], s39 offen lds
    s_add_u32 m0, s62, 16384
    s_add_u32 s39, s43, 0
    buffer_load_dwordx4 v241, s[8:11], s39 offen lds
    s_add_u32 m0, s62, 8192
    s_add_u32 s39, s42, 73728
    buffer_load_dwordx4 v240, s[4:7], s39 offen lds
    s_add_u32 m0, s62, 24576
    s_add_u32 s39, s43, 294912
    buffer_load_dwordx4 v241, s[8:11], s39 offen lds
    s_barrier
    s_add_u32 m0, s62, 36864
    s_add_u32 s39, s42, 128
    buffer_load_dwordx4 v240, s[4:7], s39 offen lds
    s_add_u32 m0, s62, 53248
    s_add_u32 s39, s43, 589824
    buffer_load_dwordx4 v241, s[8:11], s39 offen lds
    s_add_u32 m0, s62, 45056
    s_add_u32 s39, s42, 73856
    buffer_load_dwordx4 v240, s[4:7], s39 offen lds
    s_add_u32 m0, s62, 61440
    s_add_u32 s39, s43, 884736
    buffer_load_dwordx4 v241, s[8:11], s39 offen lds
    s_add_u32 m0, s62, 73728
    s_add_u32 s39, s42, 256
    buffer_load_dwordx4 v240, s[4:7], s39 offen lds
    s_add_u32 m0, s62, 90112
    s_add_u32 s39, s43, 1179648
    buffer_load_dwordx4 v241, s[8:11], s39 offen lds
    s_add_u32 m0, s62, 81920
    s_add_u32 s39, s42, 73984
    buffer_load_dwordx4 v240, s[4:7], s39 offen lds
    s_add_u32 m0, s62, 98304
    s_add_u32 s39, s43, 1474560
    buffer_load_dwordx4 v241, s[8:11], s39 offen lds
    s_lshr_b32 s38, s2, 3
    s_lshl_b32 s38, s38, 6
    v_add_u32 v248, s38, v243
    v_and_b32 v176, 1023, v248
    v_mul_u32_u24 v176, 1152, v176
    v_lshrrev_b32 v250, 10, v248
    v_lshl_add_u32 v176, v250, 7, v176
    s_lshr_b32 s94, s28, 3
    s_mul_i32 s94, s94, 1179648
    v_lshrrev_b32 v177, 3, v248
    v_mul_u32_u24 v177, 9216, v177
    v_and_b32 v251, 3, v248
    v_bfe_u32 v255, v248, 1, 1
    v_mul_u32_u24 v255, 3, v255
    v_add_u32 v251, v251, v255
    v_bfe_u32 v255, v248, 2, 1
    v_mul_u32_u24 v255, 9, v255
    v_add_u32 v251, v251, v255
    v_lshl_add_u32 v177, v251, 7, v177
    s_mul_i32 s95, s29, 2304
    v_lshrrev_b32 v178, 4, v248
    v_mul_u32_u24 v178, 9216, v178
    v_and_b32 v255, 7, v248
    v_min_u32 v255, 4, v255
    v_cmp_le_u32 vcc, 3, v255
    v_add_u32 v255, 2, v255
    s_nop 1
    v_cndmask_b32 v251, 0, 2, vcc
    v_add_u32 v255, v255, v251
    v_bfe_u32 v251, v248, 3, 1
    v_mul_u32_u24 v251, 9, v251
    v_add_u32 v255, v255, v251
    v_lshl_add_u32 v178, v255, 7, v178
    v_lshlrev_b32 v179, 7, v248
    s_mul_i32 s96, s29, 1327104
    v_lshrrev_b32 v248, 3, v243
    v_mul_u32_u24 v242, 9216, v248
    v_bfe_u32 v249, v243, 2, 1
    v_bfe_u32 v250, v243, 4, 1
    v_xor_b32 v249, v249, v250
    v_lshlrev_b32 v249, 6, v249
    v_and_b32 v250, 3, v243
    v_lshlrev_b32 v250, 4, v250
    v_add3_u32 v242, v242, v249, v250
    v_and_b32 v248, 31, v243
    s_lshl_b32 s38, s33, 12
    v_lshlrev_b32 v249, 7, v248
    v_add_u32 v249, s38, v249
    v_bfe_u32 v250, v243, 1, 3
    v_lshrrev_b32 v251, 5, v243
    v_xor_b32 v250, v250, v251
    v_lshlrev_b32 v250, 4, v250
    v_add_u32 v232, v249, v250
    v_xor_b32 v233, 32, v232
    v_xor_b32 v234, 64, v232
    v_xor_b32 v235, 0x60, v232
    v_lshrrev_b32 v248, 5, v243
    v_bfe_u32 v249, v243, 2, 2
    v_lshl_add_u32 v248, v248, 3, v249
    v_lshlrev_b32 v248, 8, v248
    v_bfe_u32 v250, v243, 4, 1
    v_lshlrev_b32 v250, 5, v250
    v_and_b32 v251, 3, v243
    v_lshlrev_b32 v251, 3, v251
    v_add3_u32 v248, v248, v250, v251
    v_add_u32 v248, 16384, v248
    s_lshl_b32 s38, s34, 1
    v_xor_b32 v250, s38, v249
    v_lshl_add_u32 v236, v250, 6, v248
    v_xor_b32 v237, 64, v236
    v_lshrrev_b32 v248, 5, v243
    v_lshl_add_u32 v248, v248, 3, v249
    v_lshlrev_b32 v248, 7, v248
    v_bfe_u32 v250, v243, 4, 1
    v_lshlrev_b32 v250, 5, v250
    v_add3_u32 v248, v248, v250, v251
    v_bfe_u32 v250, v243, 3, 1
    v_lshl_add_u32 v238, v250, 6, v248
    v_xor_b32 v239, 64, v238
    v_bfe_u32 v248, v243, 4, 1
    v_lshlrev_b32 v248, 10, v248
    v_lshrrev_b32 v249, 5, v243
    v_lshlrev_b32 v249, 8, v249
    v_and_b32 v250, 15, v243
    v_lshlrev_b32 v250, 4, v250
    v_add3_u32 v244, v248, v249, v250
    s_lshl_b32 s38, s28, 2
    s_add_u32 s38, s38, s33
    s_mul_i32 s39, s38, 144
    s_mul_i32 s40, s31, 9
    s_add_u32 s40, s39, s40
    s_lshl_b32 s46, s40, 11
    s_mul_i32 s40, s29, 36
    s_add_u32 s40, s39, s40
    s_mul_i32 s41, s34, 18
    s_add_u32 s40, s40, s41
    s_lshl_b32 s53, s40, 11
    s_lshl_b32 s38, s28, 2
    s_add_u32 s38, s38, s29
    s_lshl_b32 s38, s38, 2
    s_add_u32 s38, s38, s33
    s_lshl_b32 s38, s38, 8
    s_add_u32 s60, s38, 67108864
    s_lshl_b32 s39, s30, 2
    s_add_u32 s47, s60, s39
    s_mul_i32 s38, s29, 1327104
    s_lshl_b32 s39, s30, 8
    s_add_u32 s54, s38, s39
    s_mul_i32 s39, s33, 4608
    s_add_u32 s54, s54, s39
    s_lshl_b32 s39, s30, 5
    s_add_u32 s55, s38, s39
    s_add_u32 s55, s55, 1024
    s_mul_i32 s39, s33, 331776
    s_add_u32 s55, s55, s39
    s_waitcnt vmcnt(8)
    s_barrier
    ds_read_b128 v[0:3], v232 offset:0
    ds_read_b64_tr_b16 v[208:209], v236 offset:0
    ds_read_b64_tr_b16 v[210:211], v236 offset:1024
    ds_read_b64_tr_b16 v[212:213], v237 offset:0
    ds_read_b64_tr_b16 v[214:215], v237 offset:1024
    ds_read_b128 v[4:7], v233 offset:0
    ds_read_b64_tr_b16 v[216:217], v236 offset:4096
    ds_read_b64_tr_b16 v[218:219], v236 offset:5120
    ds_read_b64_tr_b16 v[220:221], v237 offset:4096
    ds_read_b64_tr_b16 v[222:223], v237 offset:5120
    s_waitcnt lgkmcnt(5)
    v_mfma_f32_32x32x16_bf16 v[144:159], v[208:211], v[0:3], 0
    ds_read_b128 v[8:11], v234 offset:0
    ds_read_b64_tr_b16 v[224:225], v236 offset:8192
    ds_read_b64_tr_b16 v[226:227], v236 offset:9216
    s_add_u32 m0, s62, 110592
    s_add_u32 s39, s42, 384
    buffer_load_dwordx4 v240, s[4:7], s39 offen lds
    v_mfma_f32_32x32x16_bf16 v[160:175], v[212:215], v[0:3], 0
    ds_read_b64_tr_b16 v[228:229], v237 offset:8192
    ds_read_b64_tr_b16 v[230:231], v237 offset:9216
    s_add_u32 m0, s62, 126976
    s_add_u32 s39, s43, 1769472
    buffer_load_dwordx4 v241, s[8:11], s39 offen lds
    s_waitcnt lgkmcnt(5)
    v_mfma_f32_32x32x16_bf16 v[144:159], v[216:219], v[4:7], v[144:159]
    ds_read_b128 v[12:15], v235 offset:0
    ds_read_b64_tr_b16 v[208:209], v236 offset:12288
    ds_read_b64_tr_b16 v[210:211], v236 offset:13312
    s_add_u32 m0, s62, 118784
    s_add_u32 s39, s42, 74112
    buffer_load_dwordx4 v240, s[4:7], s39 offen lds
    v_mfma_f32_32x32x16_bf16 v[160:175], v[220:223], v[4:7], v[160:175]
    ds_read_b64_tr_b16 v[212:213], v237 offset:12288
    ds_read_b64_tr_b16 v[214:215], v237 offset:13312
    s_add_u32 m0, s62, 135168
    s_add_u32 s39, s43, 2064384
    buffer_load_dwordx4 v241, s[8:11], s39 offen lds
    s_waitcnt vmcnt(8) lgkmcnt(0)
    s_barrier
    s_waitcnt lgkmcnt(5)
    v_mfma_f32_32x32x16_bf16 v[144:159], v[224:227], v[8:11], v[144:159]
    ds_read_b128 v[16:19], v232 offset:36864
    ds_read_b64_tr_b16 v[216:217], v236 offset:36864
    ds_read_b64_tr_b16 v[218:219], v236 offset:37888
    s_add_u32 m0, s62, 0
    s_add_u32 s39, s42, 512
    buffer_load_dwordx4 v240, s[4:7], s39 offen lds
    v_mfma_f32_32x32x16_bf16 v[160:175], v[228:231], v[8:11], v[160:175]
    ds_read_b64_tr_b16 v[220:221], v237 offset:36864
    ds_read_b64_tr_b16 v[222:223], v237 offset:37888
    s_add_u32 m0, s62, 16384
    s_add_u32 s39, s43, 2359296
    buffer_load_dwordx4 v241, s[8:11], s39 offen lds
    s_waitcnt lgkmcnt(5)
    v_mfma_f32_32x32x16_bf16 v[144:159], v[208:211], v[12:15], v[144:159]
    ds_read_b128 v[20:23], v233 offset:36864
    ds_read_b64_tr_b16 v[224:225], v236 offset:40960
    ds_read_b64_tr_b16 v[226:227], v236 offset:41984
    s_add_u32 m0, s62, 8192
    s_add_u32 s39, s42, 74240
    buffer_load_dwordx4 v240, s[4:7], s39 offen lds
    v_mfma_f32_32x32x16_bf16 v[160:175], v[212:215], v[12:15], v[160:175]
    ds_read_b64_tr_b16 v[228:229], v237 offset:40960
    ds_read_b64_tr_b16 v[230:231], v237 offset:41984
    s_add_u32 m0, s62, 24576
    s_add_u32 s39, s43, 2654208
    buffer_load_dwordx4 v241, s[8:11], s39 offen lds
    s_waitcnt lgkmcnt(5)
    v_mfma_f32_32x32x16_bf16 v[144:159], v[216:219], v[16:19], v[144:159]
    ds_read_b128 v[24:27], v234 offset:36864
    ds_read_b64_tr_b16 v[208:209], v236 offset:45056
    ds_read_b64_tr_b16 v[210:211], v236 offset:46080
    v_mfma_f32_32x32x16_bf16 v[160:175], v[220:223], v[16:19], v[160:175]
    ds_read_b64_tr_b16 v[212:213], v237 offset:45056
    ds_read_b64_tr_b16 v[214:215], v237 offset:46080
    s_waitcnt lgkmcnt(5)
    v_mfma_f32_32x32x16_bf16 v[144:159], v[224:227], v[20:23], v[144:159]
    ds_read_b128 v[28:31], v235 offset:36864
    ds_read_b64_tr_b16 v[216:217], v236 offset:49152
    ds_read_b64_tr_b16 v[218:219], v236 offset:50176
    v_mfma_f32_32x32x16_bf16 v[160:175], v[228:231], v[20:23], v[160:175]
    ds_read_b64_tr_b16 v[220:221], v237 offset:49152
    ds_read_b64_tr_b16 v[222:223], v237 offset:50176
    s_waitcnt vmcnt(8) lgkmcnt(0)
    s_barrier
    s_cmp_lg_u32 s32, 4
    s_cbranch_scc1 L_pfs_1
    s_add_u32 s48, s95, 0
    buffer_load_dword v247, v178, s[8:11], s48 offen
L_pfs_1:
    v_add_u32 v232, 73728, v232
    v_add_u32 v233, 73728, v233
    v_add_u32 v234, 73728, v234
    v_add_u32 v235, 73728, v235
    v_add_u32 v236, 73728, v236
    v_add_u32 v237, 73728, v237
    s_waitcnt lgkmcnt(5)
    v_mfma_f32_32x32x16_bf16 v[144:159], v[208:211], v[24:27], v[144:159]
    ds_read_b128 v[32:35], v232 offset:0
    ds_read_b64_tr_b16 v[224:225], v236 offset:0
    ds_read_b64_tr_b16 v[226:227], v236 offset:1024
    s_add_u32 m0, s62, 36864
    s_add_u32 s39, s42, 640
    buffer_load_dwordx4 v240, s[4:7], s39 offen lds
    v_mfma_f32_32x32x16_bf16 v[160:175], v[212:215], v[24:27], v[160:175]
    ds_read_b64_tr_b16 v[228:229], v237 offset:0
    ds_read_b64_tr_b16 v[230:231], v237 offset:1024
    s_add_u32 m0, s62, 53248
    s_add_u32 s39, s43, 2949120
    buffer_load_dwordx4 v241, s[8:11], s39 offen lds
    s_waitcnt lgkmcnt(5)
    v_mfma_f32_32x32x16_bf16 v[144:159], v[216:219], v[28:31], v[144:159]
    ds_read_b128 v[36:39], v233 offset:0
    ds_read_b64_tr_b16 v[208:209], v236 offset:4096
    ds_read_b64_tr_b16 v[210:211], v236 offset:5120
    s_add_u32 m0, s62, 45056
    s_add_u32 s39, s42, 74368
    buffer_load_dwordx4 v240, s[4:7], s39 offen lds
    v_mfma_f32_32x32x16_bf16 v[160:175], v[220:223], v[28:31], v[160:175]
    ds_read_b64_tr_b16 v[212:213], v237 offset:4096
    ds_read_b64_tr_b16 v[214:215], v237 offset:5120
    s_add_u32 m0, s62, 61440
    s_add_u32 s39, s43, 3244032
    buffer_load_dwordx4 v241, s[8:11], s39 offen lds
    s_waitcnt lgkmcnt(5)
    v_mfma_f32_32x32x16_bf16 v[144:159], v[224:227], v[32:35], v[144:159]
    ds_read_b128 v[40:43], v234 offset:0
    ds_read_b64_tr_b16 v[216:217], v236 offset:8192
    ds_read_b64_tr_b16 v[218:219], v236 offset:9216
    v_mfma_f32_32x32x16_bf16 v[160:175], v[228:231], v[32:35], v[160:175]
    ds_read_b64_tr_b16 v[220:221], v237 offset:8192
    ds_read_b64_tr_b16 v[222:223], v237 offset:9216
    s_waitcnt lgkmcnt(5)
    v_mfma_f32_32x32x16_bf16 v[144:159], v[208:211], v[36:39], v[144:159]
    ds_read_b128 v[44:47], v235 offset:0
    ds_read_b64_tr_b16 v[224:225], v236 offset:12288
    ds_read_b64_tr_b16 v[226:227], v236 offset:13312
    v_mfma_f32_32x32x16_bf16 v[160:175], v[212:215], v[36:39], v[160:175]
    ds_read_b64_tr_b16 v[228:229], v237 offset:12288
    ds_read_b64_tr_b16 v[230:231], v237 offset:13312
    s_waitcnt vmcnt(8) lgkmcnt(0)
    s_barrier
    s_cmp_lg_u32 s32, 5
    s_cbranch_scc1 L_pfs_2
    s_add_u32 s48, s95, 1179648
    buffer_load_dword v247, v178, s[8:11], s48 offen
L_pfs_2:
    s_waitcnt lgkmcnt(5)
    v_mfma_f32_32x32x16_bf16 v[144:159], v[216:219], v[40:43], v[144:159]
    ds_read_b128 v[48:51], v232 offset:36864
    ds_read_b64_tr_b16 v[208:209], v236 offset:36864
    ds_read_b64_tr_b16 v[210:211], v236 offset:37888
    s_add_u32 m0, s62, 73728
    s_add_u32 s39, s42, 768
    buffer_load_dwordx4 v240, s[4:7], s39 offen lds
    v_mfma_f32_32x32x16_bf16 v[160:175], v[220:223], v[40:43], v[160:175]
    ds_read_b64_tr_b16 v[212:213], v237 offset:36864
    ds_read_b64_tr_b16 v[214:215], v237 offset:37888
    s_add_u32 m0, s62, 90112
    s_add_u32 s39, s43, 3538944
    buffer_load_dwordx4 v241, s[8:11], s39 offen lds
    s_waitcnt lgkmcnt(5)
    v_mfma_f32_32x32x16_bf16 v[144:159], v[224:227], v[44:47], v[144:159]
    ds_read_b128 v[52:55], v233 offset:36864
    ds_read_b64_tr_b16 v[216:217], v236 offset:40960
    ds_read_b64_tr_b16 v[218:219], v236 offset:41984
    s_add_u32 m0, s62, 81920
    s_add_u32 s39, s42, 74496
    buffer_load_dwordx4 v240, s[4:7], s39 offen lds
    v_mfma_f32_32x32x16_bf16 v[160:175], v[228:231], v[44:47], v[160:175]
    ds_read_b64_tr_b16 v[220:221], v237 offset:40960
    ds_read_b64_tr_b16 v[222:223], v237 offset:41984
    s_add_u32 m0, s62, 98304
    s_add_u32 s39, s43, 3833856
    buffer_load_dwordx4 v241, s[8:11], s39 offen lds
    s_waitcnt lgkmcnt(5)
    v_mfma_f32_32x32x16_bf16 v[144:159], v[208:211], v[48:51], v[144:159]
    ds_read_b128 v[56:59], v234 offset:36864
    ds_read_b64_tr_b16 v[224:225], v236 offset:45056
    ds_read_b64_tr_b16 v[226:227], v236 offset:46080
    v_mfma_f32_32x32x16_bf16 v[160:175], v[212:215], v[48:51], v[160:175]
    ds_read_b64_tr_b16 v[228:229], v237 offset:45056
    ds_read_b64_tr_b16 v[230:231], v237 offset:46080
    s_waitcnt lgkmcnt(5)
    v_mfma_f32_32x32x16_bf16 v[144:159], v[216:219], v[52:55], v[144:159]
    ds_read_b128 v[60:63], v235 offset:36864
    ds_read_b64_tr_b16 v[208:209], v236 offset:49152
    ds_read_b64_tr_b16 v[210:211], v236 offset:50176
    v_mfma_f32_32x32x16_bf16 v[160:175], v[220:223], v[52:55], v[160:175]
    ds_read_b64_tr_b16 v[212:213], v237 offset:49152
    ds_read_b64_tr_b16 v[214:215], v237 offset:50176
    s_waitcnt vmcnt(8) lgkmcnt(0)
    s_barrier
    s_cmp_lg_u32 s32, 6
    s_cbranch_scc1 L_pfs_3
    s_add_u32 s48, s95, 2359296
    buffer_load_dword v247, v178, s[8:11], s48 offen
L_pfs_3:
    s_cmp_lg_u32 s32, 4
    s_cbranch_scc1 L_no_nonce3
    buffer_load_dword v252, v254, s[24:27], 0 offen sc1
L_no_nonce3:
    v_subrev_u32 v232, 73728, v232
    v_subrev_u32 v233, 73728, v233
    v_subrev_u32 v234, 73728, v234
    v_subrev_u32 v235, 73728, v235
    v_subrev_u32 v236, 73728, v236
    v_subrev_u32 v237, 73728, v237
    s_waitcnt lgkmcnt(5)
    v_mfma_f32_32x32x16_bf16 v[144:159], v[224:227], v[56:59], v[144:159]
    ds_read_b128 v[64:67], v232 offset:0
    ds_read_b64_tr_b16 v[216:217], v236 offset:0
    ds_read_b64_tr_b16 v[218:219], v236 offset:1024
    s_add_u32 m0, s62, 110592
    s_add_u32 s39, s42, 896
    buffer_load_dwordx4 v240, s[4:7], s39 offen lds
    v_mfma_f32_32x32x16_bf16 v[160:175], v[228:231], v[56:59], v[160:175]
    ds_read_b64_tr_b16 v[220:221], v237 offset:0
    ds_read_b64_tr_b16 v[222:223], v237 offset:1024
    s_add_u32 m0, s62, 126976
    s_add_u32 s39, s43, 4128768
    buffer_load_dwordx4 v241, s[8:11], s39 offen lds
    s_waitcnt lgkmcnt(5)
    v_mfma_f32_32x32x16_bf16 v[144:159], v[208:211], v[60:63], v[144:159]
    ds_read_b128 v[68:71], v233 offset:0
    ds_read_b64_tr_b16 v[224:225], v236 offset:4096
    ds_read_b64_tr_b16 v[226:227], v236 offset:5120
    s_add_u32 m0, s62, 118784
    s_add_u32 s39, s42, 74624
    buffer_load_dwordx4 v240, s[4:7], s39 offen lds
    v_mfma_f32_32x32x16_bf16 v[160:175], v[212:215], v[60:63], v[160:175]
    ds_read_b64_tr_b16 v[228:229], v237 offset:4096
    ds_read_b64_tr_b16 v[230:231], v237 offset:5120
    s_add_u32 m0, s62, 135168
    s_add_u32 s39, s43, 4423680
    buffer_load_dwordx4 v241, s[8:11], s39 offen lds
    s_waitcnt lgkmcnt(5)
    v_mfma_f32_32x32x16_bf16 v[144:159], v[216:219], v[64:67], v[144:159]
    ds_read_b128 v[72:75], v234 offset:0
    ds_read_b64_tr_b16 v[208:209], v236 offset:8192
    ds_read_b64_tr_b16 v[210:211], v236 offset:9216
    v_mfma_f32_32x32x16_bf16 v[160:175], v[220:223], v[64:67], v[160:175]
    ds_read_b64_tr_b16 v[212:213], v237 offset:8192
    ds_read_b64_tr_b16 v[214:215], v237 offset:9216
    s_waitcnt lgkmcnt(5)
    v_mfma_f32_32x32x16_bf16 v[144:159], v[224:227], v[68:71], v[144:159]
    ds_read_b128 v[76:79], v235 offset:0
    ds_read_b64_tr_b16 v[216:217], v236 offset:12288
    ds_read_b64_tr_b16 v[218:219], v236 offset:13312
    v_mfma_f32_32x32x16_bf16 v[160:175], v[228:231], v[68:71], v[160:175]
    ds_read_b64_tr_b16 v[220:221], v237 offset:12288
    ds_read_b64_tr_b16 v[222:223], v237 offset:13312
    s_waitcnt vmcnt(8) lgkmcnt(0)
    s_barrier
    s_cmp_lg_u32 s32, 7
    s_cbranch_scc1 L_pfs_4
    s_add_u32 s48, s95, 3538944
    buffer_load_dword v247, v178, s[8:11], s48 offen
L_pfs_4:
    s_waitcnt lgkmcnt(5)
    v_mfma_f32_32x32x16_bf16 v[144:159], v[208:211], v[72:75], v[144:159]
    ds_read_b128 v[80:83], v232 offset:36864
    ds_read_b64_tr_b16 v[224:225], v236 offset:36864
    ds_read_b64_tr_b16 v[226:227], v236 offset:37888
    s_add_u32 m0, s62, 0
    s_add_u32 s39, s42, 1024
    buffer_load_dwordx4 v240, s[4:7], s39 offen lds
    v_mfma_f32_32x32x16_bf16 v[160:175], v[212:215], v[72:75], v[160:175]
    ds_read_b64_tr_b16 v[228:229], v237 offset:36864
    ds_read_b64_tr_b16 v[230:231], v237 offset:37888
    s_add_u32 m0, s62, 16384
    s_add_u32 s39, s43, 4718592
    buffer_load_dwordx4 v241, s[8:11], s39 offen lds
    s_waitcnt lgkmcnt(5)
    v_mfma_f32_32x32x16_bf16 v[144:159], v[216:219], v[76:79], v[144:159]
    ds_read_b128 v[84:87], v233 offset:36864
    ds_read_b64_tr_b16 v[208:209], v236 offset:40960
    ds_read_b64_tr_b16 v[210:211], v236 offset:41984
    s_add_u32 m0, s62, 8192
    s_add_u32 s39, s42, 74752
    buffer_load_dwordx4 v240, s[4:7], s39 offen lds
    v_mfma_f32_32x32x16_bf16 v[160:175], v[220:223], v[76:79], v[160:175]
    ds_read_b64_tr_b16 v[212:213], v237 offset:40960
    ds_read_b64_tr_b16 v[214:215], v237 offset:41984
    s_add_u32 m0, s62, 24576
    s_add_u32 s39, s43, 5013504
    buffer_load_dwordx4 v241, s[8:11], s39 offen lds
    s_waitcnt lgkmcnt(5)
    v_mfma_f32_32x32x16_bf16 v[144:159], v[224:227], v[80:83], v[144:159]
    ds_read_b128 v[88:91], v234 offset:36864
    ds_read_b64_tr_b16 v[216:217], v236 offset:45056
    ds_read_b64_tr_b16 v[218:219], v236 offset:46080
    v_mfma_f32_32x32x16_bf16 v[160:175], v[228:231], v[80:83], v[160:175]
    ds_read_b64_tr_b16 v[220:221], v237 offset:45056
    ds_read_b64_tr_b16 v[222:223], v237 offset:46080
    s_waitcnt lgkmcnt(5)
    v_mfma_f32_32x32x16_bf16 v[144:159], v[208:211], v[84:87], v[144:159]
    ds_read_b128 v[92:95], v235 offset:36864
    ds_read_b64_tr_b16 v[224:225], v236 offset:49152
    ds_read_b64_tr_b16 v[226:227], v236 offset:50176
    v_mfma_f32_32x32x16_bf16 v[160:175], v[212:215], v[84:87], v[160:175]
    ds_read_b64_tr_b16 v[228:229], v237 offset:49152
    ds_read_b64_tr_b16 v[230:231], v237 offset:50176
    s_waitcnt vmcnt(8) lgkmcnt(0)
    s_barrier
    s_cmp_lg_u32 s32, 4
    s_cbranch_scc1 L_pfs_5
    s_add_u32 s48, s95, 4718592
    buffer_load_dword v247, v178, s[8:11], s48 offen
L_pfs_5:
    v_add_u32 v232, 73728, v232
    v_add_u32 v233, 73728, v233
    v_add_u32 v234, 73728, v234
    v_add_u32 v235, 73728, v235
    v_add_u32 v236, 73728, v236
    v_add_u32 v237, 73728, v237
    s_waitcnt lgkmcnt(5)
    v_mfma_f32_32x32x16_bf16 v[144:159], v[216:219], v[88:91], v[144:159]
    ds_read_b128 v[96:99], v232 offset:0
    ds_read_b64_tr_b16 v[208:209], v236 offset:0
    ds_read_b64_tr_b16 v[210:211], v236 offset:1024
    s_mul_i32 s40, s32, 73728
    s_add_u32 s40, s40, s36
    v_mfma_f32_32x32x16_bf16 v[160:175], v[220:223], v[88:91], v[160:175]
    ds_read_b64_tr_b16 v[212:213], v237 offset:0
    ds_read_b64_tr_b16 v[214:215], v237 offset:1024
    s_add_u32 m0, s62, 36864
    s_add_u32 s39, s40, 256
    buffer_load_dwordx4 v242, s[8:11], s39 offen lds
    s_waitcnt lgkmcnt(5)
    v_mfma_f32_32x32x16_bf16 v[144:159], v[224:227], v[92:95], v[144:159]
    ds_read_b128 v[100:103], v233 offset:0
    ds_read_b64_tr_b16 v[216:217], v236 offset:4096
    ds_read_b64_tr_b16 v[218:219], v236 offset:5120
    s_add_u32 m0, s62, 45056
    s_add_u32 s39, s40, 590080
    buffer_load_dwordx4 v242, s[8:11], s39 offen lds
    v_mfma_f32_32x32x16_bf16 v[160:175], v[228:231], v[92:95], v[160:175]
    ds_read_b64_tr_b16 v[220:221], v237 offset:4096
    ds_read_b64_tr_b16 v[222:223], v237 offset:5120
    s_add_u32 m0, s62, 53248
    s_add_u32 s39, s40, 1179904
    buffer_load_dwordx4 v242, s[8:11], s39 offen lds
    s_waitcnt lgkmcnt(5)
    v_mfma_f32_32x32x16_bf16 v[144:159], v[208:211], v[96:99], v[144:159]
    ds_read_b128 v[104:107], v234 offset:0
    ds_read_b64_tr_b16 v[224:225], v236 offset:8192
    ds_read_b64_tr_b16 v[226:227], v236 offset:9216
    s_add_u32 m0, s62, 61440
    s_add_u32 s39, s40, 1769728
    buffer_load_dwordx4 v242, s[8:11], s39 offen lds
    v_mfma_f32_32x32x16_bf16 v[160:175], v[212:215], v[96:99], v[160:175]
    ds_read_b64_tr_b16 v[228:229], v237 offset:8192
    ds_read_b64_tr_b16 v[230:231], v237 offset:9216
    s_cmp_ge_u32 s32, 4
    s_cbranch_scc1 L_t18_9
    s_add_u32 m0, s62, 69632
    s_add_u32 s39, s40, 2359552
    buffer_load_dwordx4 v242, s[8:11], s39 offen lds
L_t18_9:
    s_waitcnt lgkmcnt(5)
    v_mfma_f32_32x32x16_bf16 v[144:159], v[216:219], v[100:103], v[144:159]
    ds_read_b128 v[108:111], v235 offset:0
    ds_read_b64_tr_b16 v[208:209], v236 offset:12288
    ds_read_b64_tr_b16 v[210:211], v236 offset:13312
    v_mfma_f32_32x32x16_bf16 v[160:175], v[220:223], v[100:103], v[160:175]
    ds_read_b64_tr_b16 v[212:213], v237 offset:12288
    ds_read_b64_tr_b16 v[214:215], v237 offset:13312
    s_waitcnt vmcnt(8) lgkmcnt(0)
    s_barrier
    s_cmp_lg_u32 s32, 5
    s_cbranch_scc1 L_pfs_6
    s_add_u32 s48, s96, 0
    buffer_load_dword v247, v179, s[12:15], s48 offen
L_pfs_6:
    v_lshrrev_b32 v240, 2, v243
    v_mul_u32_u24 v240, 9216, v240
    v_and_b32 v255, 3, v243
    v_lshl_add_u32 v240, v255, 4, v240
    s_waitcnt lgkmcnt(5)
    v_mfma_f32_32x32x16_bf16 v[144:159], v[224:227], v[104:107], v[144:159]
    ds_read_b128 v[112:115], v232 offset:36864
    ds_read_b64_tr_b16 v[216:217], v236 offset:36864
    ds_read_b64_tr_b16 v[218:219], v236 offset:37888
    s_mul_i32 s40, s32, 73728
    s_add_u32 s40, s40, s36
    v_mfma_f32_32x32x16_bf16 v[160:175], v[228:231], v[104:107], v[160:175]
    ds_read_b64_tr_b16 v[220:221], v237 offset:36864
    ds_read_b64_tr_b16 v[222:223], v237 offset:37888
    s_add_u32 m0, s62, 73728
    s_add_u32 s39, s40, 2654464
    buffer_load_dwordx4 v242, s[8:11], s39 offen lds
    s_waitcnt lgkmcnt(5)
    v_mfma_f32_32x32x16_bf16 v[144:159], v[208:211], v[108:111], v[144:159]
    ds_read_b128 v[116:119], v233 offset:36864
    ds_read_b64_tr_b16 v[224:225], v236 offset:40960
    ds_read_b64_tr_b16 v[226:227], v236 offset:41984
    s_add_u32 m0, s62, 81920
    s_add_u32 s39, s40, 3244288
    buffer_load_dwordx4 v242, s[8:11], s39 offen lds
    v_mfma_f32_32x32x16_bf16 v[160:175], v[212:215], v[108:111], v[160:175]
    ds_read_b64_tr_b16 v[228:229], v237 offset:40960
    ds_read_b64_tr_b16 v[230:231], v237 offset:41984
    s_add_u32 m0, s62, 90112
    s_add_u32 s39, s40, 3834112
    buffer_load_dwordx4 v242, s[8:11], s39 offen lds
    s_waitcnt lgkmcnt(5)
    v_mfma_f32_32x32x16_bf16 v[144:159], v[216:219], v[112:115], v[144:159]
    ds_read_b128 v[120:123], v234 offset:36864
    ds_read_b64_tr_b16 v[208:209], v236 offset:45056
    ds_read_b64_tr_b16 v[210:211], v236 offset:46080
    s_add_u32 m0, s62, 98304
    s_add_u32 s39, s40, 4423936
    buffer_load_dwordx4 v242, s[8:11], s39 offen lds
    v_mfma_f32_32x32x16_bf16 v[160:175], v[220:223], v[112:115], v[160:175]
    ds_read_b64_tr_b16 v[212:213], v237 offset:45056
    ds_read_b64_tr_b16 v[214:215], v237 offset:46080
    s_cmp_ge_u32 s32, 4
    s_cbranch_scc1 L_t18_10
    s_add_u32 m0, s62, 106496
    s_add_u32 s39, s40, 5013760
    buffer_load_dwordx4 v242, s[8:11], s39 offen lds
L_t18_10:
    s_waitcnt lgkmcnt(5)
    v_mfma_f32_32x32x16_bf16 v[144:159], v[224:227], v[116:119], v[144:159]
    ds_read_b128 v[124:127], v235 offset:36864
    ds_read_b64_tr_b16 v[216:217], v236 offset:49152
    ds_read_b64_tr_b16 v[218:219], v236 offset:50176
    v_mfma_f32_32x32x16_bf16 v[160:175], v[228:231], v[116:119], v[160:175]
    ds_read_b64_tr_b16 v[220:221], v237 offset:49152
    ds_read_b64_tr_b16 v[222:223], v237 offset:50176
    s_waitcnt vmcnt(8) lgkmcnt(0)
    s_cmp_lg_u32 s32, 4
    s_cbranch_scc1 L_no_nonce2
    s_mov_b32 s61, 0
L_nonce_chk:
    v_readfirstlane_b32 s38, v252
    s_cmp_lg_u32 s38, 0
    s_cbranch_scc1 L_nonce_ok
    s_add_u32 s61, s61, 1
    s_cmp_gt_u32 s61, 200000
    s_cbranch_scc1 L_nonce_ok
    buffer_load_dword v252, v254, s[24:27], 0 offen sc1
    s_waitcnt vmcnt(0)
    s_branch L_nonce_chk
L_nonce_ok:
    v_mov_b32 v253, s38
    v_mov_b32 v254, 147456
    ds_write_b32 v254, v253
L_no_nonce2:
    s_barrier
    s_cmp_lg_u32 s32, 6
    s_cbranch_scc1 L_pfs_7
    s_add_u32 s48, s96, 262144
    buffer_load_dword v247, v179, s[12:15], s48 offen
L_pfs_7:
    v_subrev_u32 v232, 73728, v232
    v_subrev_u32 v233, 73728, v233
    v_subrev_u32 v234, 73728, v234
    v_subrev_u32 v235, 73728, v235
    v_subrev_u32 v236, 73728, v236
    v_subrev_u32 v237, 73728, v237
    s_waitcnt lgkmcnt(5)
    v_mfma_f32_32x32x16_bf16 v[144:159], v[208:211], v[120:123], v[144:159]
    ds_read_b128 v[128:131], v232 offset:0
    ds_read_b64_tr_b16 v[224:225], v236 offset:0
    ds_read_b64_tr_b16 v[226:227], v236 offset:1024
    s_mul_i32 s40, s32, 73728
    s_add_u32 s40, s40, s36
    s_mul_i32 s41, s32, 147456
    s_add_u32 s41, s41, s50
    v_mfma_f32_32x32x16_bf16 v[160:175], v[212:215], v[120:123], v[160:175]
    ds_read_b64_tr_b16 v[228:229], v237 offset:0
    ds_read_b64_tr_b16 v[230:231], v237 offset:1024
    s_add_u32 m0, s62, 110592
    s_add_u32 s39, s40, 384
    buffer_load_dwordx4 v242, s[8:11], s39 offen lds
    s_waitcnt lgkmcnt(5)
    v_mfma_f32_32x32x16_bf16 v[144:159], v[216:219], v[124:127], v[144:159]
    ds_read_b128 v[132:135], v233 offset:0
    ds_read_b64_tr_b16 v[208:209], v236 offset:4096
    ds_read_b64_tr_b16 v[210:211], v236 offset:5120
    s_add_u32 m0, s62, 118784
    s_add_u32 s39, s40, 590208
    buffer_load_dwordx4 v242, s[8:11], s39 offen lds
    v_mfma_f32_32x32x16_bf16 v[160:175], v[220:223], v[124:127], v[160:175]
    ds_read_b64_tr_b16 v[212:213], v237 offset:4096
    ds_read_b64_tr_b16 v[214:215], v237 offset:5120
    s_add_u32 m0, s62, 126976
    s_add_u32 s39, s40, 1180032
    buffer_load_dwordx4 v242, s[8:11], s39 offen lds
    s_waitcnt lgkmcnt(5)
    v_mfma_f32_32x32x16_bf16 v[144:159], v[224:227], v[128:131], v[144:159]
    ds_read_b128 v[136:139], v234 offset:0
    ds_read_b64_tr_b16 v[216:217], v236 offset:8192
    ds_read_b64_tr_b16 v[218:219], v236 offset:9216
    s_add_u32 m0, s62, 135168
    s_add_u32 s39, s41, 0
    buffer_load_dwordx4 v240, s[8:11], s39 offen lds
    v_mfma_f32_32x32x16_bf16 v[160:175], v[228:231], v[128:131], v[160:175]
    ds_read_b64_tr_b16 v[220:221], v237 offset:8192
    ds_read_b64_tr_b16 v[222:223], v237 offset:9216
    s_cmp_ge_u32 s32, 4
    s_cbranch_scc1 L_x8_11
    s_add_u32 m0, s62, 143360
    s_add_u32 s39, s41, 1179648
    buffer_load_dwordx4 v240, s[8:11], s39 offen lds
L_x8_11:
    s_waitcnt lgkmcnt(5)
    v_mfma_f32_32x32x16_bf16 v[144:159], v[208:211], v[132:135], v[144:159]
    ds_read_b128 v[140:143], v235 offset:0
    ds_read_b64_tr_b16 v[224:225], v236 offset:12288
    ds_read_b64_tr_b16 v[226:227], v236 offset:13312
    v_mfma_f32_32x32x16_bf16 v[160:175], v[212:215], v[132:135], v[160:175]
    ds_read_b64_tr_b16 v[228:229], v237 offset:12288
    ds_read_b64_tr_b16 v[230:231], v237 offset:13312
    s_waitcnt vmcnt(8) lgkmcnt(0)
    s_barrier
    s_waitcnt lgkmcnt(5)
    v_mfma_f32_32x32x16_bf16 v[144:159], v[216:219], v[136:139], v[144:159]
    v_mfma_f32_32x32x16_bf16 v[160:175], v[220:223], v[136:139], v[160:175]
    s_waitcnt lgkmcnt(0)
    v_mfma_f32_32x32x16_bf16 v[144:159], v[224:227], v[140:143], v[144:159]
    v_mfma_f32_32x32x16_bf16 v[160:175], v[228:231], v[140:143], v[160:175]
    v_mov_b32 v248, 147456
    ds_read_b32 v249, v248
    s_lshl_b32 s62, s33, 10
    s_waitcnt lgkmcnt(0)
    v_readfirstlane_b32 s35, v249
    s_cmp_lg_u32 s34, 0
    s_cbranch_scc1 L_pathB
    v_add_u32 v245, 36864, v238
    v_add_u32 v246, 36864, v239
    ds_read_b64_tr_b16 v[208:209], v245 offset:0
    ds_read_b64_tr_b16 v[210:211], v245 offset:512
    ds_read_b64_tr_b16 v[212:213], v246 offset:0
    ds_read_b64_tr_b16 v[214:215], v246 offset:512
    ds_read_b64_tr_b16 v[216:217], v245 offset:2048
    ds_read_b64_tr_b16 v[218:219], v245 offset:2560
    ds_read_b64_tr_b16 v[220:221], v246 offset:2048
    ds_read_b64_tr_b16 v[222:223], v246 offset:2560
    s_waitcnt lgkmcnt(6)
    v_mfma_f32_32x32x16_bf16 v[176:191], v[208:211], v[0:3], 0
    ds_read_b64_tr_b16 v[224:225], v245 offset:4096
    ds_read_b64_tr_b16 v[226:227], v245 offset:4608
    v_lshrrev_b32 v248, 4, v243
    v_mul_u32_u24 v232, 1152, v248
    s_and_b32 s48, s33, 1
    s_waitcnt lgkmcnt(6)
    v_mfma_f32_32x32x16_bf16 v[192:207], v[212:215], v[0:3], 0
    ds_read_b64_tr_b16 v[228:229], v246 offset:4096
    ds_read_b64_tr_b16 v[230:231], v246 offset:4608
    s_mul_i32 s40, s33, 73728
    s_add_u32 s40, s40, s36
    s_mul_i32 s41, s33, 147456
    s_add_u32 s41, s41, s50
    s_waitcnt lgkmcnt(6)
    v_mfma_f32_32x32x16_bf16 v[176:191], v[216:219], v[4:7], v[176:191]
    ds_read_b64_tr_b16 v[208:209], v245 offset:6144
    ds_read_b64_tr_b16 v[210:211], v245 offset:6656
    s_lshl_b32 s48, s48, 2
    v_add_u32 v248, s48, v248
    v_bfe_u32 v249, v243, 1, 3
    s_waitcnt lgkmcnt(6)
    v_mfma_f32_32x32x16_bf16 v[192:207], v[220:223], v[4:7], v[192:207]
    ds_read_b64_tr_b16 v[212:213], v246 offset:6144
    ds_read_b64_tr_b16 v[214:215], v246 offset:6656
    s_add_u32 m0, s62, 0
    s_add_u32 s39, s40, 1769856
    buffer_load_dwordx4 v242, s[8:11], s39 offen lds
    s_waitcnt lgkmcnt(6)
    v_mfma_f32_32x32x16_bf16 v[176:191], v[224:227], v[8:11], v[176:191]
    ds_read_b64_tr_b16 v[216:217], v245 offset:8192
    ds_read_b64_tr_b16 v[218:219], v245 offset:8704
    v_xor_b32 v249, v249, v248
    v_lshl_add_u32 v232, v249, 5, v232
    v_and_b32 v249, 1, v243
    s_waitcnt lgkmcnt(6)
    v_mfma_f32_32x32x16_bf16 v[192:207], v[228:231], v[8:11], v[192:207]
    ds_read_b64_tr_b16 v[220:221], v246 offset:8192
    ds_read_b64_tr_b16 v[222:223], v246 offset:8704
    s_add_u32 m0, s62, 4096
    s_add_u32 s39, s40, 2064768
    buffer_load_dwordx4 v242, s[8:11], s39 offen lds
    s_waitcnt lgkmcnt(6)
    v_mfma_f32_32x32x16_bf16 v[176:191], v[208:211], v[12:15], v[176:191]
    ds_read_b64_tr_b16 v[224:225], v245 offset:10240
    ds_read_b64_tr_b16 v[226:227], v245 offset:10752
    v_lshl_add_u32 v232, v249, 4, v232
    v_lshrrev_b32 v248, 1, v243
    v_mul_u32_u24 v234, 1152, v248
    s_waitcnt lgkmcnt(6)
    v_mfma_f32_32x32x16_bf16 v[192:207], v[212:215], v[12:15], v[192:207]
    ds_read_b64_tr_b16 v[228:229], v246 offset:10240
    ds_read_b64_tr_b16 v[230:231], v246 offset:10752
    s_add_u32 m0, s62, 8192
    s_add_u32 s39, s40, 2359680
    buffer_load_dwordx4 v242, s[8:11], s39 offen lds
    s_waitcnt lgkmcnt(6)
    v_mfma_f32_32x32x16_bf16 v[176:191], v[216:219], v[16:19], v[176:191]
    ds_read_b64_tr_b16 v[208:209], v245 offset:12288
    ds_read_b64_tr_b16 v[210:211], v245 offset:12800
    v_lshl_add_u32 v234, v249, 4, v234
    s_waitcnt lgkmcnt(6)
    v_mfma_f32_32x32x16_bf16 v[192:207], v[220:223], v[16:19], v[192:207]
    ds_read_b64_tr_b16 v[212:213], v246 offset:12288
    ds_read_b64_tr_b16 v[214:215], v246 offset:12800
    s_add_u32 m0, s62, 12288
    s_add_u32 s39, s40, 2654592
    buffer_load_dwordx4 v242, s[8:11], s39 offen lds
    s_waitcnt lgkmcnt(6)
    v_mfma_f32_32x32x16_bf16 v[176:191], v[224:227], v[20:23], v[176:191]
    ds_read_b64_tr_b16 v[216:217], v245 offset:14336
    ds_read_b64_tr_b16 v[218:219], v245 offset:14848
    s_waitcnt lgkmcnt(6)
    v_mfma_f32_32x32x16_bf16 v[192:207], v[228:231], v[20:23], v[192:207]
    ds_read_b64_tr_b16 v[220:221], v246 offset:14336
    ds_read_b64_tr_b16 v[222:223], v246 offset:14848
    s_add_u32 m0, s62, 16384
    s_add_u32 s39, s40, 2949504
    buffer_load_dwordx4 v242, s[8:11], s39 offen lds
    s_waitcnt lgkmcnt(6)
    v_mfma_f32_32x32x16_bf16 v[176:191], v[208:211], v[24:27], v[176:191]
    ds_read_b64_tr_b16 v[224:225], v245 offset:16384
    ds_read_b64_tr_b16 v[226:227], v245 offset:16896
    s_waitcnt lgkmcnt(6)
    v_mfma_f32_32x32x16_bf16 v[192:207], v[212:215], v[24:27], v[192:207]
    ds_read_b64_tr_b16 v[228:229], v246 offset:16384
    ds_read_b64_tr_b16 v[230:231], v246 offset:16896
    s_add_u32 m0, s62, 20480
    s_add_u32 s39, s40, 3244416
    buffer_load_dwordx4 v242, s[8:11], s39 offen lds
    s_waitcnt lgkmcnt(6)
    v_mfma_f32_32x32x16_bf16 v[176:191], v[216:219], v[28:31], v[176:191]
    ds_read_b64_tr_b16 v[208:209], v245 offset:18432
    ds_read_b64_tr_b16 v[210:211], v245 offset:18944
    s_waitcnt lgkmcnt(6)
    v_mfma_f32_32x32x16_bf16 v[192:207], v[220:223], v[28:31], v[192:207]
    ds_read_b64_tr_b16 v[212:213], v246 offset:18432
    ds_read_b64_tr_b16 v[214:215], v246 offset:18944
    s_add_u32 m0, s62, 24576
    s_add_u32 s39, s41, 1769472
    buffer_load_dwordx4 v240, s[8:11], s39 offen lds
    s_waitcnt lgkmcnt(6)
    v_mfma_f32_32x32x16_bf16 v[176:191], v[224:227], v[32:35], v[176:191]
    ds_read_b64_tr_b16 v[216:217], v245 offset:20480
    ds_read_b64_tr_b16 v[218:219], v245 offset:20992
    s_waitcnt lgkmcnt(6)
    v_mfma_f32_32x32x16_bf16 v[192:207], v[228:231], v[32:35], v[192:207]
    ds_read_b64_tr_b16 v[220:221], v246 offset:20480
    ds_read_b64_tr_b16 v[222:223], v246 offset:20992
    s_add_u32 m0, s62, 28672
    s_add_u32 s39, s41, 2359296
    buffer_load_dwordx4 v240, s[8:11], s39 offen lds
    s_waitcnt lgkmcnt(6)
    v_mfma_f32_32x32x16_bf16 v[176:191], v[208:211], v[36:39], v[176:191]
    ds_read_b64_tr_b16 v[224:225], v245 offset:22528
    ds_read_b64_tr_b16 v[226:227], v245 offset:23040
    s_waitcnt lgkmcnt(6)
    v_mfma_f32_32x32x16_bf16 v[192:207], v[212:215], v[36:39], v[192:207]
    ds_read_b64_tr_b16 v[228:229], v246 offset:22528
    ds_read_b64_tr_b16 v[230:231], v246 offset:23040
    s_add_u32 m0, s62, 32768
    s_add_u32 s39, s41, 2949120
    buffer_load_dwordx4 v240, s[8:11], s39 offen lds
    s_waitcnt lgkmcnt(6)
    v_mfma_f32_32x32x16_bf16 v[176:191], v[216:219], v[40:43], v[176:191]
    ds_read_b64_tr_b16 v[208:209], v245 offset:24576
    ds_read_b64_tr_b16 v[210:211], v245 offset:25088
    s_waitcnt lgkmcnt(6)
    v_mfma_f32_32x32x16_bf16 v[192:207], v[220:223], v[40:43], v[192:207]
    ds_read_b64_tr_b16 v[212:213], v246 offset:24576
    ds_read_b64_tr_b16 v[214:215], v246 offset:25088
    s_waitcnt lgkmcnt(6)
    v_mfma_f32_32x32x16_bf16 v[176:191], v[224:227], v[44:47], v[176:191]
    ds_read_b64_tr_b16 v[216:217], v245 offset:26624
    ds_read_b64_tr_b16 v[218:219], v245 offset:27136
    s_waitcnt lgkmcnt(6)
    v_mfma_f32_32x32x16_bf16 v[192:207], v[228:231], v[44:47], v[192:207]
    ds_read_b64_tr_b16 v[220:221], v246 offset:26624
    ds_read_b64_tr_b16 v[222:223], v246 offset:27136
    s_waitcnt lgkmcnt(6)
    v_mfma_f32_32x32x16_bf16 v[176:191], v[208:211], v[48:51], v[176:191]
    ds_read_b64_tr_b16 v[224:225], v245 offset:28672
    ds_read_b64_tr_b16 v[226:227], v245 offset:29184
    s_waitcnt lgkmcnt(6)
    v_mfma_f32_32x32x16_bf16 v[192:207], v[212:215], v[48:51], v[192:207]
    ds_read_b64_tr_b16 v[228:229], v246 offset:28672
    ds_read_b64_tr_b16 v[230:231], v246 offset:29184
    s_waitcnt lgkmcnt(6)
    v_mfma_f32_32x32x16_bf16 v[176:191], v[216:219], v[52:55], v[176:191]
    ds_read_b64_tr_b16 v[208:209], v245 offset:30720
    ds_read_b64_tr_b16 v[210:211], v245 offset:31232
    s_waitcnt lgkmcnt(6)
    v_mfma_f32_32x32x16_bf16 v[192:207], v[220:223], v[52:55], v[192:207]
    ds_read_b64_tr_b16 v[212:213], v246 offset:30720
    ds_read_b64_tr_b16 v[214:215], v246 offset:31232
    s_waitcnt lgkmcnt(6)
    v_mfma_f32_32x32x16_bf16 v[176:191], v[224:227], v[56:59], v[176:191]
    ds_read_b64_tr_b16 v[216:217], v245 offset:32768
    ds_read_b64_tr_b16 v[218:219], v245 offset:33280
    s_waitcnt lgkmcnt(6)
    v_mfma_f32_32x32x16_bf16 v[192:207], v[228:231], v[56:59], v[192:207]
    ds_read_b64_tr_b16 v[220:221], v246 offset:32768
    ds_read_b64_tr_b16 v[222:223], v246 offset:33280
    s_waitcnt lgkmcnt(6)
    v_mfma_f32_32x32x16_bf16 v[176:191], v[208:211], v[60:63], v[176:191]
    ds_read_b64_tr_b16 v[224:225], v245 offset:34816
    ds_read_b64_tr_b16 v[226:227], v245 offset:35328
    s_waitcnt lgkmcnt(6)
    v_mfma_f32_32x32x16_bf16 v[192:207], v[212:215], v[60:63], v[192:207]
    ds_read_b64_tr_b16 v[228:229], v246 offset:34816
    ds_read_b64_tr_b16 v[230:231], v246 offset:35328
    s_waitcnt vmcnt(13) lgkmcnt(0)
    s_barrier
    v_add_u32 v245, 73728, v238
    v_add_u32 v246, 73728, v239
    s_waitcnt lgkmcnt(6)
    v_mfma_f32_32x32x16_bf16 v[176:191], v[216:219], v[64:67], v[176:191]
    ds_read_b64_tr_b16 v[208:209], v245 offset:0
    ds_read_b64_tr_b16 v[210:211], v245 offset:512
    s_waitcnt lgkmcnt(6)
    v_mfma_f32_32x32x16_bf16 v[192:207], v[220:223], v[64:67], v[192:207]
    ds_read_b64_tr_b16 v[212:213], v246 offset:0
    ds_read_b64_tr_b16 v[214:215], v246 offset:512
    s_mul_i32 s40, s33, 73728
    s_add_u32 s40, s40, s36
    s_mul_i32 s41, s33, 147456
    s_add_u32 s41, s41, s50
    s_waitcnt lgkmcnt(6)
    v_mfma_f32_32x32x16_bf16 v[176:191], v[224:227], v[68:71], v[176:191]
    ds_read_b64_tr_b16 v[216:217], v245 offset:2048
    ds_read_b64_tr_b16 v[218:219], v245 offset:2560
    s_waitcnt lgkmcnt(6)
    v_mfma_f32_32x32x16_bf16 v[192:207], v[228:231], v[68:71], v[192:207]
    ds_read_b64_tr_b16 v[220:221], v246 offset:2048
    ds_read_b64_tr_b16 v[222:223], v246 offset:2560
    s_add_u32 m0, s62, 36864
    s_add_u32 s39, s40, 3539328
    buffer_load_dwordx4 v242, s[8:11], s39 offen lds
    s_waitcnt lgkmcnt(6)
    v_mfma_f32_32x32x16_bf16 v[176:191], v[208:211], v[72:75], v[176:191]
    ds_read_b64_tr_b16 v[224:225], v245 offset:4096
    ds_read_b64_tr_b16 v[226:227], v245 offset:4608
    s_waitcnt lgkmcnt(6)
    v_mfma_f32_32x32x16_bf16 v[192:207], v[212:215], v[72:75], v[192:207]
    ds_read_b64_tr_b16 v[228:229], v246 offset:4096
    ds_read_b64_tr_b16 v[230:231], v246 offset:4608
    s_add_u32 m0, s62, 40960
    s_add_u32 s39, s40, 3834240
    buffer_load_dwordx4 v242, s[8:11], s39 offen lds
    s_waitcnt lgkmcnt(6)
    v_mfma_f32_32x32x16_bf16 v[176:191], v[216:219], v[76:79], v[176:191]
    ds_read_b64_tr_b16 v[208:209], v245 offset:6144
    ds_read_b64_tr_b16 v[210:211], v245 offset:6656
    s_waitcnt lgkmcnt(6)
    v_mfma_f32_32x32x16_bf16 v[192:207], v[220:223], v[76:79], v[192:207]
    ds_read_b64_tr_b16 v[212:213], v246 offset:6144
    ds_read_b64_tr_b16 v[214:215], v246 offset:6656
    s_add_u32 m0, s62, 45056
    s_add_u32 s39, s40, 4129152
    buffer_load_dwordx4 v242, s[8:11], s39 offen lds
    s_waitcnt lgkmcnt(6)
    v_mfma_f32_32x32x16_bf16 v[176:191], v[224:227], v[80:83], v[176:191]
    ds_read_b64_tr_b16 v[216:217], v245 offset:8192
    ds_read_b64_tr_b16 v[218:219], v245 offset:8704
    s_waitcnt lgkmcnt(6)
    v_mfma_f32_32x32x16_bf16 v[192:207], v[228:231], v[80:83], v[192:207]
    ds_read_b64_tr_b16 v[220:221], v246 offset:8192
    ds_read_b64_tr_b16 v[222:223], v246 offset:8704
    s_add_u32 m0, s62, 49152
    s_add_u32 s39, s40, 4424064
    buffer_load_dwordx4 v242, s[8:11], s39 offen lds
    s_waitcnt lgkmcnt(6)
    v_mfma_f32_32x32x16_bf16 v[176:191], v[208:211], v[84:87], v[176:191]
    ds_read_b64_tr_b16 v[224:225], v245 offset:10240
    ds_read_b64_tr_b16 v[226:227], v245 offset:10752
    s_waitcnt lgkmcnt(6)
    v_mfma_f32_32x32x16_bf16 v[192:207], v[212:215], v[84:87], v[192:207]
    ds_read_b64_tr_b16 v[228:229], v246 offset:10240
    ds_read_b64_tr_b16 v[230:231], v246 offset:10752
    s_add_u32 m0, s62, 53248
    s_add_u32 s39, s40, 4718976
    buffer_load_dwordx4 v242, s[8:11], s39 offen lds
    s_waitcnt lgkmcnt(6)
    v_mfma_f32_32x32x16_bf16 v[176:191], v[216:219], v[88:91], v[176:191]
    ds_read_b64_tr_b16 v[208:209], v245 offset:12288
    ds_read_b64_tr_b16 v[210:211], v245 offset:12800
    s_waitcnt lgkmcnt(6)
    v_mfma_f32_32x32x16_bf16 v[192:207], v[220:223], v[88:91], v[192:207]
    ds_read_b64_tr_b16 v[212:213], v246 offset:12288
    ds_read_b64_tr_b16 v[214:215], v246 offset:12800
    s_add_u32 m0, s62, 57344
    s_add_u32 s39, s40, 5013888
    buffer_load_dwordx4 v242, s[8:11], s39 offen lds
    s_waitcnt lgkmcnt(6)
    v_mfma_f32_32x32x16_bf16 v[176:191], v[224:227], v[92:95], v[176:191]
    ds_read_b64_tr_b16 v[216:217], v245 offset:14336
    ds_read_b64_tr_b16 v[218:219], v245 offset:14848
    s_waitcnt lgkmcnt(6)
    v_mfma_f32_32x32x16_bf16 v[192:207], v[228:231], v[92:95], v[192:207]
    ds_read_b64_tr_b16 v[220:221], v246 offset:14336
    ds_read_b64_tr_b16 v[222:223], v246 offset:14848
    s_add_u32 m0, s62, 61440
    s_add_u32 s39, s41, 3538944
    buffer_load_dwordx4 v240, s[8:11], s39 offen lds
    s_waitcnt lgkmcnt(6)
    v_mfma_f32_32x32x16_bf16 v[176:191], v[208:211], v[96:99], v[176:191]
    ds_read_b64_tr_b16 v[224:225], v245 offset:16384
    ds_read_b64_tr_b16 v[226:227], v245 offset:16896
    s_waitcnt lgkmcnt(6)
    v_mfma_f32_32x32x16_bf16 v[192:207], v[212:215], v[96:99], v[192:207]
    ds_read_b64_tr_b16 v[228:229], v246 offset:16384
    ds_read_b64_tr_b16 v[230:231], v246 offset:16896
    s_add_u32 m0, s62, 65536
    s_add_u32 s39, s41, 4128768
    buffer_load_dwordx4 v240, s[8:11], s39 offen lds
    s_waitcnt lgkmcnt(6)
    v_mfma_f32_32x32x16_bf16 v[176:191], v[216:219], v[100:103], v[176:191]
    ds_read_b64_tr_b16 v[208:209], v245 offset:18432
    ds_read_b64_tr_b16 v[210:211], v245 offset:18944
    s_waitcnt lgkmcnt(6)
    v_mfma_f32_32x32x16_bf16 v[192:207], v[220:223], v[100:103], v[192:207]
    ds_read_b64_tr_b16 v[212:213], v246 offset:18432
    ds_read_b64_tr_b16 v[214:215], v246 offset:18944
    s_add_u32 m0, s62, 69632
    s_add_u32 s39, s41, 4718592
    buffer_load_dwordx4 v240, s[8:11], s39 offen lds
    s_waitcnt lgkmcnt(6)
    v_mfma_f32_32x32x16_bf16 v[176:191], v[224:227], v[104:107], v[176:191]
    ds_read_b64_tr_b16 v[216:217], v245 offset:20480
    ds_read_b64_tr_b16 v[218:219], v245 offset:20992
    s_waitcnt lgkmcnt(6)
    v_mfma_f32_32x32x16_bf16 v[192:207], v[228:231], v[104:107], v[192:207]
    ds_read_b64_tr_b16 v[220:221], v246 offset:20480
    ds_read_b64_tr_b16 v[222:223], v246 offset:20992
    s_waitcnt lgkmcnt(6)
    v_mfma_f32_32x32x16_bf16 v[176:191], v[208:211], v[108:111], v[176:191]
    ds_read_b64_tr_b16 v[224:225], v245 offset:22528
    ds_read_b64_tr_b16 v[226:227], v245 offset:23040
    s_waitcnt lgkmcnt(6)
    v_mfma_f32_32x32x16_bf16 v[192:207], v[212:215], v[108:111], v[192:207]
    ds_read_b64_tr_b16 v[228:229], v246 offset:22528
    ds_read_b64_tr_b16 v[230:231], v246 offset:23040
    s_waitcnt lgkmcnt(6)
    v_mfma_f32_32x32x16_bf16 v[176:191], v[216:219], v[112:115], v[176:191]
    ds_read_b64_tr_b16 v[208:209], v245 offset:24576
    ds_read_b64_tr_b16 v[210:211], v245 offset:25088
    s_waitcnt lgkmcnt(6)
    v_mfma_f32_32x32x16_bf16 v[192:207], v[220:223], v[112:115], v[192:207]
    ds_read_b64_tr_b16 v[212:213], v246 offset:24576
    ds_read_b64_tr_b16 v[214:215], v246 offset:25088
    s_waitcnt lgkmcnt(6)
    v_mfma_f32_32x32x16_bf16 v[176:191], v[224:227], v[116:119], v[176:191]
    ds_read_b64_tr_b16 v[216:217], v245 offset:26624
    ds_read_b64_tr_b16 v[218:219], v245 offset:27136
    s_waitcnt lgkmcnt(6)
    v_mfma_f32_32x32x16_bf16 v[192:207], v[228:231], v[116:119], v[192:207]
    ds_read_b64_tr_b16 v[220:221], v246 offset:26624
    ds_read_b64_tr_b16 v[222:223], v246 offset:27136
    s_waitcnt lgkmcnt(6)
    v_mfma_f32_32x32x16_bf16 v[176:191], v[208:211], v[120:123], v[176:191]
    ds_read_b64_tr_b16 v[224:225], v245 offset:28672
    ds_read_b64_tr_b16 v[226:227], v245 offset:29184
    s_waitcnt lgkmcnt(6)
    v_mfma_f32_32x32x16_bf16 v[192:207], v[212:215], v[120:123], v[192:207]
    ds_read_b64_tr_b16 v[228:229], v246 offset:28672
    ds_read_b64_tr_b16 v[230:231], v246 offset:29184
    s_waitcnt lgkmcnt(6)
    v_mfma_f32_32x32x16_bf16 v[176:191], v[216:219], v[124:127], v[176:191]
    ds_read_b64_tr_b16 v[208:209], v245 offset:30720
    ds_read_b64_tr_b16 v[210:211], v245 offset:31232
    s_waitcnt lgkmcnt(6)
    v_mfma_f32_32x32x16_bf16 v[192:207], v[220:223], v[124:127], v[192:207]
    ds_read_b64_tr_b16 v[212:213], v246 offset:30720
    ds_read_b64_tr_b16 v[214:215], v246 offset:31232
    s_waitcnt lgkmcnt(6)
    v_mfma_f32_32x32x16_bf16 v[176:191], v[224:227], v[128:131], v[176:191]
    ds_read_b64_tr_b16 v[216:217], v245 offset:32768
    ds_read_b64_tr_b16 v[218:219], v245 offset:33280
    s_waitcnt lgkmcnt(6)
    v_mfma_f32_32x32x16_bf16 v[192:207], v[228:231], v[128:131], v[192:207]
    ds_read_b64_tr_b16 v[220:221], v246 offset:32768
    ds_read_b64_tr_b16 v[222:223], v246 offset:33280
    s_waitcnt lgkmcnt(6)
    v_mfma_f32_32x32x16_bf16 v[176:191], v[208:211], v[132:135], v[176:191]
    ds_read_b64_tr_b16 v[224:225], v245 offset:34816
    ds_read_b64_tr_b16 v[226:227], v245 offset:35328
    s_waitcnt lgkmcnt(6)
    v_mfma_f32_32x32x16_bf16 v[192:207], v[212:215], v[132:135], v[192:207]
    ds_read_b64_tr_b16 v[228:229], v246 offset:34816
    ds_read_b64_tr_b16 v[230:231], v246 offset:35328
    s_waitcnt vmcnt(18) lgkmcnt(0)
    s_barrier
    s_waitcnt lgkmcnt(6)
    v_mfma_f32_32x32x16_bf16 v[176:191], v[216:219], v[136:139], v[176:191]
    s_waitcnt lgkmcnt(4)
    v_mfma_f32_32x32x16_bf16 v[192:207], v[220:223], v[136:139], v[192:207]
    s_waitcnt lgkmcnt(2)
    v_mfma_f32_32x32x16_bf16 v[176:191], v[224:227], v[140:143], v[176:191]
    s_waitcnt lgkmcnt(0)
    v_mfma_f32_32x32x16_bf16 v[192:207], v[228:231], v[140:143], v[192:207]
    v_mul_f32 v248, s51, v160
    v_mul_f32 v249, s51, v161
    v_mul_f32 v250, s51, v162
    v_mul_f32 v251, s51, v163
    v_exp_f32 v248, v248
    v_exp_f32 v249, v249
    v_exp_f32 v250, v250
    v_exp_f32 v251, v251
    v_add_f32 v248, 1.0, v248
    v_add_f32 v249, 1.0, v249
    v_add_f32 v250, 1.0, v250
    v_add_f32 v251, 1.0, v251
    v_rcp_f32 v248, v248
    v_rcp_f32 v249, v249
    v_rcp_f32 v250, v250
    v_rcp_f32 v251, v251
    v_mul_f32 v248, v160, v248
    v_mul_f32 v249, v161, v249
    v_mul_f32 v250, v162, v250
    v_mul_f32 v251, v163, v251
    v_cvt_pk_bf16_f32 v208, v248, v249
    v_cvt_pk_bf16_f32 v209, v250, v251
    v_mul_f32 v248, s51, v164
    v_mul_f32 v249, s51, v165
    v_mul_f32 v250, s51, v166
    v_mul_f32 v251, s51, v167
    v_exp_f32 v248, v248
    v_exp_f32 v249, v249
    v_exp_f32 v250, v250
    v_exp_f32 v251, v251
    v_add_f32 v248, 1.0, v248
    v_add_f32 v249, 1.0, v249
    v_add_f32 v250, 1.0, v250
    v_add_f32 v251, 1.0, v251
    v_rcp_f32 v248, v248
    v_rcp_f32 v249, v249
    v_rcp_f32 v250, v250
    v_rcp_f32 v251, v251
    v_mul_f32 v248, v164, v248
    v_mul_f32 v249, v165, v249
    v_mul_f32 v250, v166, v250
    v_mul_f32 v251, v167, v251
    v_cvt_pk_bf16_f32 v210, v248, v249
    v_cvt_pk_bf16_f32 v211, v250, v251
    s_add_u32 s38, s46, 2048
    buffer_store_dwordx4 v[208:211], v244, s[20:23], s38 offen offset:0 sc1
    v_mul_f32 v248, s51, v168
    v_mul_f32 v249, s51, v169
    v_mul_f32 v250, s51, v170
    v_mul_f32 v251, s51, v171
    v_exp_f32 v248, v248
    v_exp_f32 v249, v249
    v_exp_f32 v250, v250
    v_exp_f32 v251, v251
    v_add_f32 v248, 1.0, v248
    v_add_f32 v249, 1.0, v249
    v_add_f32 v250, 1.0, v250
    v_add_f32 v251, 1.0, v251
    v_rcp_f32 v248, v248
    v_rcp_f32 v249, v249
    v_rcp_f32 v250, v250
    v_rcp_f32 v251, v251
    v_mul_f32 v248, v168, v248
    v_mul_f32 v249, v169, v249
    v_mul_f32 v250, v170, v250
    v_mul_f32 v251, v171, v251
    v_cvt_pk_bf16_f32 v212, v248, v249
    v_cvt_pk_bf16_f32 v213, v250, v251
    v_mul_f32 v248, s51, v172
    v_mul_f32 v249, s51, v173
    v_mul_f32 v250, s51, v174
    v_mul_f32 v251, s51, v175
    v_exp_f32 v248, v248
    v_exp_f32 v249, v249
    v_exp_f32 v250, v250
    v_exp_f32 v251, v251
    v_add_f32 v248, 1.0, v248
    v_add_f32 v249, 1.0, v249
    v_add_f32 v250, 1.0, v250
    v_add_f32 v251, 1.0, v251
    v_rcp_f32 v248, v248
    v_rcp_f32 v249, v249
    v_rcp_f32 v250, v250
    v_rcp_f32 v251, v251
    v_mul_f32 v248, v172, v248
    v_mul_f32 v249, v173, v249
    v_mul_f32 v250, v174, v250
    v_mul_f32 v251, v175, v251
    v_cvt_pk_bf16_f32 v214, v248, v249
    v_cvt_pk_bf16_f32 v215, v250, v251
    buffer_store_dwordx4 v[212:215], v244, s[20:23], s38 offen offset:512 sc1
    v_lshlrev_b32 v165, 4, v243
    v_lshlrev_b32 v164, 2, v243
    v_bfe_u32 v169, v243, 4, 1
    v_bfe_u32 v170, v243, 2, 2
    v_lshl_add_u32 v169, v169, 2, v170
    v_lshrrev_b32 v168, 5, v243
    v_lshl_add_u32 v168, v168, 4, v169
    v_and_b32 v170, 3, v243
    v_lshlrev_b32 v170, 3, v170
    v_lshl_add_u32 v160, v168, 8, v170
    v_lshl_add_u32 v160, v169, 5, v160
    s_lshl_b32 s48, s34, 14
    v_add_u32 v160, s48, v160
    v_lshl_add_u32 v166, v168, 5, v170
    s_lshl_b32 s48, s34, 11
    s_add_u32 s48, s48, 32768
    v_add_u32 v166, s48, v166
    buffer_load_dword v163, v164, s[20:23], s60 offen sc1
    v_mul_f32 v248, s51, v144
    v_mul_f32 v249, s51, v145
    v_mul_f32 v250, s51, v146
    v_mul_f32 v251, s51, v147
    v_exp_f32 v248, v248
    v_exp_f32 v249, v249
    v_exp_f32 v250, v250
    v_exp_f32 v251, v251
    v_add_f32 v248, 1.0, v248
    v_add_f32 v249, 1.0, v249
    v_add_f32 v250, 1.0, v250
    v_add_f32 v251, 1.0, v251
    v_rcp_f32 v248, v248
    v_rcp_f32 v249, v249
    v_rcp_f32 v250, v250
    v_rcp_f32 v251, v251
    v_mul_f32 v248, v144, v248
    v_mul_f32 v249, v145, v249
    v_mul_f32 v250, v146, v250
    v_mul_f32 v251, v147, v251
    v_cvt_pk_bf16_f32 v216, v248, v249
    v_cvt_pk_bf16_f32 v217, v250, v251
    v_mul_f32 v248, s51, v148
    v_mul_f32 v249, s51, v149
    v_mul_f32 v250, s51, v150
    v_mul_f32 v251, s51, v151
    v_exp_f32 v248, v248
    v_exp_f32 v249, v249
    v_exp_f32 v250, v250
    v_exp_f32 v251, v251
    v_add_f32 v248, 1.0, v248
    v_add_f32 v249, 1.0, v249
    v_add_f32 v250, 1.0, v250
    v_add_f32 v251, 1.0, v251
    v_rcp_f32 v248, v248
    v_rcp_f32 v249, v249
    v_rcp_f32 v250, v250
    v_rcp_f32 v251, v251
    v_mul_f32 v248, v148, v248
    v_mul_f32 v249, v149, v249
    v_mul_f32 v250, v150, v250
    v_mul_f32 v251, v151, v251
    v_cvt_pk_bf16_f32 v218, v248, v249
    v_cvt_pk_bf16_f32 v219, v250, v251
    s_add_u32 s38, s46, 0
    buffer_store_dwordx4 v[216:219], v244, s[20:23], s38 offen offset:0 sc1
    v_mul_f32 v248, s51, v152
    v_mul_f32 v249, s51, v153
    v_mul_f32 v250, s51, v154
    v_mul_f32 v251, s51, v155
    v_exp_f32 v248, v248
    v_exp_f32 v249, v249
    v_exp_f32 v250, v250
    v_exp_f32 v251, v251
    v_add_f32 v248, 1.0, v248
    v_add_f32 v249, 1.0, v249
    v_add_f32 v250, 1.0, v250
    v_add_f32 v251, 1.0, v251
    v_rcp_f32 v248, v248
    v_rcp_f32 v249, v249
    v_rcp_f32 v250, v250
    v_rcp_f32 v251, v251
    v_mul_f32 v248, v152, v248
    v_mul_f32 v249, v153, v249
    v_mul_f32 v250, v154, v250
    v_mul_f32 v251, v155, v251
    v_cvt_pk_bf16_f32 v220, v248, v249
    v_cvt_pk_bf16_f32 v221, v250, v251
    v_mul_f32 v248, s51, v156
    v_mul_f32 v249, s51, v157
    v_mul_f32 v250, s51, v158
    v_mul_f32 v251, s51, v159
    v_exp_f32 v248, v248
    v_exp_f32 v249, v249
    v_exp_f32 v250, v250
    v_exp_f32 v251, v251
    v_add_f32 v248, 1.0, v248
    v_add_f32 v249, 1.0, v249
    v_add_f32 v250, 1.0, v250
    v_add_f32 v251, 1.0, v251
    v_rcp_f32 v248, v248
    v_rcp_f32 v249, v249
    v_rcp_f32 v250, v250
    v_rcp_f32 v251, v251
    v_mul_f32 v248, v156, v248
    v_mul_f32 v249, v157, v249
    v_mul_f32 v250, v158, v250
    v_mul_f32 v251, v159, v251
    v_cvt_pk_bf16_f32 v222, v248, v249
    v_cvt_pk_bf16_f32 v223, v250, v251
    buffer_store_dwordx4 v[220:223], v244, s[20:23], s38 offen offset:512 sc1
    s_waitcnt vmcnt(2)
    s_barrier
    v_cmp_ne_u32 vcc, s35, v163
    s_and_b32 s38, vcc_lo, 0xff00
    s_cbranch_scc0 L_ok_1
    s_mov_b32 s61, 0
L_spin_1:
    buffer_load_dword v163, v164, s[20:23], s60 offen sc1
    s_add_u32 s61, s61, 1
    s_cmp_gt_u32 s61, 200000
    s_cbranch_scc1 L_ok_1
    s_waitcnt vmcnt(0)
    v_cmp_ne_u32 vcc, s35, v163
    s_and_b32 s38, vcc_lo, 0xff00
    s_cbranch_scc1 L_spin_1
L_ok_1:
    s_add_u32 s48, s53, 40960
    buffer_load_dwordx4 v[128:131], v165, s[20:23], s48 offen sc1
    v_mul_f32 v248, s51, v176
    v_mul_f32 v249, s51, v177
    v_mul_f32 v250, s51, v178
    v_mul_f32 v251, s51, v179
    v_exp_f32 v248, v248
    v_exp_f32 v249, v249
    v_exp_f32 v250, v250
    v_exp_f32 v251, v251
    v_add_f32 v248, 1.0, v248
    v_add_f32 v249, 1.0, v249
    v_add_f32 v250, 1.0, v250
    v_add_f32 v251, 1.0, v251
    v_rcp_f32 v248, v248
    v_rcp_f32 v249, v249
    v_rcp_f32 v250, v250
    v_rcp_f32 v251, v251
    v_mul_f32 v248, v176, v248
    v_mul_f32 v249, v177, v249
    v_mul_f32 v250, v178, v250
    v_mul_f32 v251, v179, v251
    v_cvt_pk_bf16_f32 v224, v248, v249
    v_cvt_pk_bf16_f32 v225, v250, v251
    buffer_load_dwordx4 v[132:135], v165, s[20:23], s48 offen offset:1024 sc1
    v_mul_f32 v248, s51, v180
    v_mul_f32 v249, s51, v181
    v_mul_f32 v250, s51, v182
    v_mul_f32 v251, s51, v183
    v_exp_f32 v248, v248
    v_exp_f32 v249, v249
    v_exp_f32 v250, v250
    v_exp_f32 v251, v251
    v_add_f32 v248, 1.0, v248
    v_add_f32 v249, 1.0, v249
    v_add_f32 v250, 1.0, v250
    v_add_f32 v251, 1.0, v251
    v_rcp_f32 v248, v248
    v_rcp_f32 v249, v249
    v_rcp_f32 v250, v250
    v_rcp_f32 v251, v251
    v_mul_f32 v248, v180, v248
    v_mul_f32 v249, v181, v249
    v_mul_f32 v250, v182, v250
    v_mul_f32 v251, v183, v251
    v_cvt_pk_bf16_f32 v226, v248, v249
    v_cvt_pk_bf16_f32 v227, v250, v251
    s_add_u32 s38, s46, 8192
    buffer_store_dwordx4 v[224:227], v244, s[20:23], s38 offen offset:0 sc1
    s_add_u32 s49, s48, 18432
    buffer_load_dwordx4 v[136:139], v165, s[20:23], s49 offen sc1
    v_mul_f32 v248, s51, v184
    v_mul_f32 v249, s51, v185
    v_mul_f32 v250, s51, v186
    v_mul_f32 v251, s51, v187
    v_exp_f32 v248, v248
    v_exp_f32 v249, v249
    v_exp_f32 v250, v250
    v_exp_f32 v251, v251
    v_add_f32 v248, 1.0, v248
    v_add_f32 v249, 1.0, v249
    v_add_f32 v250, 1.0, v250
    v_add_f32 v251, 1.0, v251
    v_rcp_f32 v248, v248
    v_rcp_f32 v249, v249
    v_rcp_f32 v250, v250
    v_rcp_f32 v251, v251
    v_mul_f32 v248, v184, v248
    v_mul_f32 v249, v185, v249
    v_mul_f32 v250, v186, v250
    v_mul_f32 v251, v187, v251
    v_cvt_pk_bf16_f32 v228, v248, v249
    v_cvt_pk_bf16_f32 v229, v250, v251
    buffer_load_dwordx4 v[140:143], v165, s[20:23], s49 offen offset:1024 sc1
    v_mul_f32 v248, s51, v188
    v_mul_f32 v249, s51, v189
    v_mul_f32 v250, s51, v190
    v_mul_f32 v251, s51, v191
    v_exp_f32 v248, v248
    v_exp_f32 v249, v249
    v_exp_f32 v250, v250
    v_exp_f32 v251, v251
    v_add_f32 v248, 1.0, v248
    v_add_f32 v249, 1.0, v249
    v_add_f32 v250, 1.0, v250
    v_add_f32 v251, 1.0, v251
    v_rcp_f32 v248, v248
    v_rcp_f32 v249, v249
    v_rcp_f32 v250, v250
    v_rcp_f32 v251, v251
    v_mul_f32 v248, v188, v248
    v_mul_f32 v249, v189, v249
    v_mul_f32 v250, v190, v250
    v_mul_f32 v251, v191, v251
    v_cvt_pk_bf16_f32 v230, v248, v249
    v_cvt_pk_bf16_f32 v231, v250, v251
    buffer_store_dwordx4 v[228:231], v244, s[20:23], s38 offen offset:512 sc1
    s_add_u32 s48, s53, 4096
    buffer_load_dwordx4 v[96:99], v165, s[20:23], s48 offen sc1
    v_mul_f32 v248, s51, v192
    v_mul_f32 v249, s51, v193
    v_mul_f32 v250, s51, v194
    v_mul_f32 v251, s51, v195
    v_exp_f32 v248, v248
    v_exp_f32 v249, v249
    v_exp_f32 v250, v250
    v_exp_f32 v251, v251
    v_add_f32 v248, 1.0, v248
    v_add_f32 v249, 1.0, v249
    v_add_f32 v250, 1.0, v250
    v_add_f32 v251, 1.0, v251
    v_rcp_f32 v248, v248
    v_rcp_f32 v249, v249
    v_rcp_f32 v250, v250
    v_rcp_f32 v251, v251
    v_mul_f32 v248, v192, v248
    v_mul_f32 v249, v193, v249
    v_mul_f32 v250, v194, v250
    v_mul_f32 v251, v195, v251
    v_cvt_pk_bf16_f32 v208, v248, v249
    v_cvt_pk_bf16_f32 v209, v250, v251
    buffer_load_dwordx4 v[100:103], v165, s[20:23], s48 offen offset:1024 sc1
    v_mul_f32 v248, s51, v196
    v_mul_f32 v249, s51, v197
    v_mul_f32 v250, s51, v198
    v_mul_f32 v251, s51, v199
    v_exp_f32 v248, v248
    v_exp_f32 v249, v249
    v_exp_f32 v250, v250
    v_exp_f32 v251, v251
    v_add_f32 v248, 1.0, v248
    v_add_f32 v249, 1.0, v249
    v_add_f32 v250, 1.0, v250
    v_add_f32 v251, 1.0, v251
    v_rcp_f32 v248, v248
    v_rcp_f32 v249, v249
    v_rcp_f32 v250, v250
    v_rcp_f32 v251, v251
    v_mul_f32 v248, v196, v248
    v_mul_f32 v249, v197, v249
    v_mul_f32 v250, v198, v250
    v_mul_f32 v251, v199, v251
    v_cvt_pk_bf16_f32 v210, v248, v249
    v_cvt_pk_bf16_f32 v211, v250, v251
    s_add_u32 s38, s46, 10240
    buffer_store_dwordx4 v[208:211], v244, s[20:23], s38 offen offset:0 sc1
    s_add_u32 s49, s48, 18432
    buffer_load_dwordx4 v[104:107], v165, s[20:23], s49 offen sc1
    v_mul_f32 v248, s51, v200
    v_mul_f32 v249, s51, v201
    v_mul_f32 v250, s51, v202
    v_mul_f32 v251, s51, v203
    v_exp_f32 v248, v248
    v_exp_f32 v249, v249
    v_exp_f32 v250, v250
    v_exp_f32 v251, v251
    v_add_f32 v248, 1.0, v248
    v_add_f32 v249, 1.0, v249
    v_add_f32 v250, 1.0, v250
    v_add_f32 v251, 1.0, v251
    v_rcp_f32 v248, v248
    v_rcp_f32 v249, v249
    v_rcp_f32 v250, v250
    v_rcp_f32 v251, v251
    v_mul_f32 v248, v200, v248
    v_mul_f32 v249, v201, v249
    v_mul_f32 v250, v202, v250
    v_mul_f32 v251, v203, v251
    v_cvt_pk_bf16_f32 v212, v248, v249
    v_cvt_pk_bf16_f32 v213, v250, v251
    buffer_load_dwordx4 v[108:111], v165, s[20:23], s49 offen offset:1024 sc1
    v_mul_f32 v248, s51, v204
    v_mul_f32 v249, s51, v205
    v_mul_f32 v250, s51, v206
    v_mul_f32 v251, s51, v207
    v_exp_f32 v248, v248
    v_exp_f32 v249, v249
    v_exp_f32 v250, v250
    v_exp_f32 v251, v251
    v_add_f32 v248, 1.0, v248
    v_add_f32 v249, 1.0, v249
    v_add_f32 v250, 1.0, v250
    v_add_f32 v251, 1.0, v251
    v_rcp_f32 v248, v248
    v_rcp_f32 v249, v249
    v_rcp_f32 v250, v250
    v_rcp_f32 v251, v251
    v_mul_f32 v248, v204, v248
    v_mul_f32 v249, v205, v249
    v_mul_f32 v250, v206, v250
    v_mul_f32 v251, v207, v251
    v_cvt_pk_bf16_f32 v214, v248, v249
    v_cvt_pk_bf16_f32 v215, v250, v251
    buffer_store_dwordx4 v[212:215], v244, s[20:23], s38 offen offset:512 sc1
    s_waitcnt vmcnt(12)
    v_lshlrev_b32 v252, 4, v243
    v_mov_b32 v253, s35
    v_cmp_gt_u32 vcc, 2, v243
    s_add_u32 s38, s47, 0
    s_and_saveexec_b64 s[58:59], vcc
    buffer_store_dword v253, v252, s[20:23], s38 offen sc1
    s_mov_b64 exec, s[58:59]
    s_barrier
    s_branch L_p2
L_pathB:
    s_nop 7
    v_mul_f32 v248, s51, v144
    v_mul_f32 v249, s51, v145
    v_mul_f32 v250, s51, v146
    v_mul_f32 v251, s51, v147
    v_exp_f32 v248, v248
    v_exp_f32 v249, v249
    v_exp_f32 v250, v250
    v_exp_f32 v251, v251
    v_add_f32 v248, 1.0, v248
    v_add_f32 v249, 1.0, v249
    v_add_f32 v250, 1.0, v250
    v_add_f32 v251, 1.0, v251
    v_rcp_f32 v248, v248
    v_rcp_f32 v249, v249
    v_rcp_f32 v250, v250
    v_rcp_f32 v251, v251
    v_mul_f32 v248, v144, v248
    v_mul_f32 v249, v145, v249
    v_mul_f32 v250, v146, v250
    v_mul_f32 v251, v147, v251
    v_cvt_pk_bf16_f32 v216, v248, v249
    v_cvt_pk_bf16_f32 v217, v250, v251
    v_mul_f32 v248, s51, v148
    v_mul_f32 v249, s51, v149
    v_mul_f32 v250, s51, v150
    v_mul_f32 v251, s51, v151
    v_exp_f32 v248, v248
    v_exp_f32 v249, v249
    v_exp_f32 v250, v250
    v_exp_f32 v251, v251
    v_add_f32 v248, 1.0, v248
    v_add_f32 v249, 1.0, v249
    v_add_f32 v250, 1.0, v250
    v_add_f32 v251, 1.0, v251
    v_rcp_f32 v248, v248
    v_rcp_f32 v249, v249
    v_rcp_f32 v250, v250
    v_rcp_f32 v251, v251
    v_mul_f32 v248, v148, v248
    v_mul_f32 v249, v149, v249
    v_mul_f32 v250, v150, v250
    v_mul_f32 v251, v151, v251
    v_cvt_pk_bf16_f32 v218, v248, v249
    v_cvt_pk_bf16_f32 v219, v250, v251
    s_add_u32 s38, s46, 4096
    buffer_store_dwordx4 v[216:219], v244, s[20:23], s38 offen offset:0 sc1
    v_mul_f32 v248, s51, v152
    v_mul_f32 v249, s51, v153
    v_mul_f32 v250, s51, v154
    v_mul_f32 v251, s51, v155
    v_exp_f32 v248, v248
    v_exp_f32 v249, v249
    v_exp_f32 v250, v250
    v_exp_f32 v251, v251
    v_add_f32 v248, 1.0, v248
    v_add_f32 v249, 1.0, v249
    v_add_f32 v250, 1.0, v250
    v_add_f32 v251, 1.0, v251
    v_rcp_f32 v248, v248
    v_rcp_f32 v249, v249
    v_rcp_f32 v250, v250
    v_rcp_f32 v251, v251
    v_mul_f32 v248, v152, v248
    v_mul_f32 v249, v153, v249
    v_mul_f32 v250, v154, v250
    v_mul_f32 v251, v155, v251
    v_cvt_pk_bf16_f32 v220, v248, v249
    v_cvt_pk_bf16_f32 v221, v250, v251
    v_mul_f32 v248, s51, v156
    v_mul_f32 v249, s51, v157
    v_mul_f32 v250, s51, v158
    v_mul_f32 v251, s51, v159
    v_exp_f32 v248, v248
    v_exp_f32 v249, v249
    v_exp_f32 v250, v250
    v_exp_f32 v251, v251
    v_add_f32 v248, 1.0, v248
    v_add_f32 v249, 1.0, v249
    v_add_f32 v250, 1.0, v250
    v_add_f32 v251, 1.0, v251
    v_rcp_f32 v248, v248
    v_rcp_f32 v249, v249
    v_rcp_f32 v250, v250
    v_rcp_f32 v251, v251
    v_mul_f32 v248, v156, v248
    v_mul_f32 v249, v157, v249
    v_mul_f32 v250, v158, v250
    v_mul_f32 v251, v159, v251
    v_cvt_pk_bf16_f32 v222, v248, v249
    v_cvt_pk_bf16_f32 v223, v250, v251
    buffer_store_dwordx4 v[220:223], v244, s[20:23], s38 offen offset:512 sc1
    v_mul_f32 v248, s51, v160
    v_mul_f32 v249, s51, v161
    v_mul_f32 v250, s51, v162
    v_mul_f32 v251, s51, v163
    v_exp_f32 v248, v248
    v_exp_f32 v249, v249
    v_exp_f32 v250, v250
    v_exp_f32 v251, v251
    v_add_f32 v248, 1.0, v248
    v_add_f32 v249, 1.0, v249
    v_add_f32 v250, 1.0, v250
    v_add_f32 v251, 1.0, v251
    v_rcp_f32 v248, v248
    v_rcp_f32 v249, v249
    v_rcp_f32 v250, v250
    v_rcp_f32 v251, v251
    v_mul_f32 v248, v160, v248
    v_mul_f32 v249, v161, v249
    v_mul_f32 v250, v162, v250
    v_mul_f32 v251, v163, v251
    v_cvt_pk_bf16_f32 v224, v248, v249
    v_cvt_pk_bf16_f32 v225, v250, v251
    v_mul_f32 v248, s51, v164
    v_mul_f32 v249, s51, v165
    v_mul_f32 v250, s51, v166
    v_mul_f32 v251, s51, v167
    v_exp_f32 v248, v248
    v_exp_f32 v249, v249
    v_exp_f32 v250, v250
    v_exp_f32 v251, v251
    v_add_f32 v248, 1.0, v248
    v_add_f32 v249, 1.0, v249
    v_add_f32 v250, 1.0, v250
    v_add_f32 v251, 1.0, v251
    v_rcp_f32 v248, v248
    v_rcp_f32 v249, v249
    v_rcp_f32 v250, v250
    v_rcp_f32 v251, v251
    v_mul_f32 v248, v164, v248
    v_mul_f32 v249, v165, v249
    v_mul_f32 v250, v166, v250
    v_mul_f32 v251, v167, v251
    v_cvt_pk_bf16_f32 v226, v248, v249
    v_cvt_pk_bf16_f32 v227, v250, v251
    s_add_u32 s38, s46, 6144
    buffer_store_dwordx4 v[224:227], v244, s[20:23], s38 offen offset:0 sc1
    v_mul_f32 v248, s51, v168
    v_mul_f32 v249, s51, v169
    v_mul_f32 v250, s51, v170
    v_mul_f32 v251, s51, v171
    v_exp_f32 v248, v248
    v_exp_f32 v249, v249
    v_exp_f32 v250, v250
    v_exp_f32 v251, v251
    v_add_f32 v248, 1.0, v248
    v_add_f32 v249, 1.0, v249
    v_add_f32 v250, 1.0, v250
    v_add_f32 v251, 1.0, v251
    v_rcp_f32 v248, v248
    v_rcp_f32 v249, v249
    v_rcp_f32 v250, v250
    v_rcp_f32 v251, v251
    v_mul_f32 v248, v168, v248
    v_mul_f32 v249, v169, v249
    v_mul_f32 v250, v170, v250
    v_mul_f32 v251, v171, v251
    v_cvt_pk_bf16_f32 v228, v248, v249
    v_cvt_pk_bf16_f32 v229, v250, v251
    v_mul_f32 v248, s51, v172
    v_mul_f32 v249, s51, v173
    v_mul_f32 v250, s51, v174
    v_mul_f32 v251, s51, v175
    v_exp_f32 v248, v248
    v_exp_f32 v249, v249
    v_exp_f32 v250, v250
    v_exp_f32 v251, v251
    v_add_f32 v248, 1.0, v248
    v_add_f32 v249, 1.0, v249
    v_add_f32 v250, 1.0, v250
    v_add_f32 v251, 1.0, v251
    v_rcp_f32 v248, v248
    v_rcp_f32 v249, v249
    v_rcp_f32 v250, v250
    v_rcp_f32 v251, v251
    v_mul_f32 v248, v172, v248
    v_mul_f32 v249, v173, v249
    v_mul_f32 v250, v174, v250
    v_mul_f32 v251, v175, v251
    v_cvt_pk_bf16_f32 v230, v248, v249
    v_cvt_pk_bf16_f32 v231, v250, v251
    buffer_store_dwordx4 v[228:231], v244, s[20:23], s38 offen offset:512 sc1
    s_waitcnt vmcnt(8)
    s_barrier
    v_lshrrev_b32 v248, 4, v243
    v_mul_u32_u24 v232, 1152, v248
    s_and_b32 s48, s33, 1
    s_lshl_b32 s48, s48, 2
    v_add_u32 v248, s48, v248
    v_bfe_u32 v249, v243, 1, 3
    v_xor_b32 v249, v249, v248
    v_lshl_add_u32 v232, v249, 5, v232
    v_and_b32 v249, 1, v243
    v_lshl_add_u32 v232, v249, 4, v232
    v_lshrrev_b32 v248, 1, v243
    v_mul_u32_u24 v234, 1152, v248
    v_lshl_add_u32 v234, v249, 4, v234
    v_lshrrev_b32 v248, 5, v243
    v_bfe_u32 v249, v243, 2, 2
    v_lshl_add_u32 v248, v248, 3, v249
    v_lshlrev_b32 v248, 6, v248
    v_bfe_u32 v249, v243, 4, 1
    v_lshlrev_b32 v249, 5, v249
    v_and_b32 v250, 3, v243
    v_lshlrev_b32 v250, 3, v250
    v_add3_u32 v236, v248, v249, v250
    v_add_u32 v236, 24576, v236
    s_waitcnt vmcnt(0)
    v_lshlrev_b32 v252, 4, v243
    v_mov_b32 v253, s35
    v_cmp_gt_u32 vcc, 2, v243
    s_add_u32 s38, s47, 32
    s_and_saveexec_b64 s[58:59], vcc
    buffer_store_dword v253, v252, s[20:23], s38 offen sc1
    s_mov_b64 exec, s[58:59]
    s_cmp_lg_u32 s32, 7
    s_cbranch_scc1 L_pfs_8
    s_add_u32 s48, s96, 524288
    buffer_load_dword v247, v179, s[12:15], s48 offen
L_pfs_8:
    s_cmp_lg_u32 s32, 4
    s_cbranch_scc1 L_pfs_9
    s_add_u32 s48, s96, 786432
    buffer_load_dword v247, v179, s[12:15], s48 offen
L_pfs_9:
    s_cmp_lg_u32 s32, 5
    s_cbranch_scc1 L_pfs_10
    s_add_u32 s48, s96, 1048576
    buffer_load_dword v247, v179, s[12:15], s48 offen
L_pfs_10:
    s_cmp_lg_u32 s32, 6
    s_cbranch_scc1 L_pfs_11
    s_add_u32 s48, s96, 1310720
    buffer_load_dword v247, v179, s[12:15], s48 offen
L_pfs_11:
    s_barrier
    v_add_u32 v245, 110592, v238
    v_add_u32 v246, 110592, v239
    v_add_u32 v237, 110592, v236
    ds_read_b64_tr_b16 v[208:209], v245 offset:0
    ds_read_b64_tr_b16 v[210:211], v245 offset:512
    ds_read_b64_tr_b16 v[212:213], v246 offset:0
    ds_read_b64_tr_b16 v[214:215], v246 offset:512
    ds_read_b64_tr_b16 v[160:161], v237 offset:0
    ds_read_b64_tr_b16 v[162:163], v237 offset:256
    ds_read_b64_tr_b16 v[216:217], v245 offset:2048
    ds_read_b64_tr_b16 v[218:219], v245 offset:2560
    ds_read_b64_tr_b16 v[220:221], v246 offset:2048
    ds_read_b64_tr_b16 v[222:223], v246 offset:2560
    ds_read_b64_tr_b16 v[164:165], v237 offset:1024
    ds_read_b64_tr_b16 v[166:167], v237 offset:1280
    s_waitcnt lgkmcnt(10)
    v_mfma_f32_32x32x16_bf16 v[176:191], v[208:211], v[0:3], 0
    ds_read_b64_tr_b16 v[224:225], v245 offset:4096
    ds_read_b64_tr_b16 v[226:227], v245 offset:4608
    s_waitcnt lgkmcnt(10)
    v_mfma_f32_32x32x16_bf16 v[192:207], v[212:215], v[0:3], 0
    ds_read_b64_tr_b16 v[228:229], v246 offset:4096
    ds_read_b64_tr_b16 v[230:231], v246 offset:4608
    s_waitcnt lgkmcnt(10)
    v_mfma_f32_32x32x16_bf16 v[144:159], v[160:163], v[0:3], 0
    ds_read_b64_tr_b16 v[168:169], v237 offset:2048
    ds_read_b64_tr_b16 v[170:171], v237 offset:2304
    s_add_u32 m0, s62, 73728
    s_add_u32 s40, s54, 73728
    buffer_load_dwordx4 v232, s[12:15], s40 offen lds
    s_waitcnt lgkmcnt(10)
    v_mfma_f32_32x32x16_bf16 v[176:191], v[216:219], v[4:7], v[176:191]
    ds_read_b64_tr_b16 v[208:209], v245 offset:6144
    ds_read_b64_tr_b16 v[210:211], v245 offset:6656
    s_waitcnt lgkmcnt(10)
    v_mfma_f32_32x32x16_bf16 v[192:207], v[220:223], v[4:7], v[192:207]
    ds_read_b64_tr_b16 v[212:213], v246 offset:6144
    ds_read_b64_tr_b16 v[214:215], v246 offset:6656
    s_waitcnt lgkmcnt(10)
    v_mfma_f32_32x32x16_bf16 v[144:159], v[164:167], v[4:7], v[144:159]
    ds_read_b64_tr_b16 v[160:161], v237 offset:3072
    ds_read_b64_tr_b16 v[162:163], v237 offset:3328
    s_add_u32 m0, s62, 81920
    s_add_u32 s40, s54, 442368
    buffer_load_dwordx4 v232, s[12:15], s40 offen lds
    s_waitcnt lgkmcnt(10)
    v_mfma_f32_32x32x16_bf16 v[176:191], v[224:227], v[8:11], v[176:191]
    ds_read_b64_tr_b16 v[216:217], v245 offset:8192
    ds_read_b64_tr_b16 v[218:219], v245 offset:8704
    s_waitcnt lgkmcnt(10)
    v_mfma_f32_32x32x16_bf16 v[192:207], v[228:231], v[8:11], v[192:207]
    ds_read_b64_tr_b16 v[220:221], v246 offset:8192
    ds_read_b64_tr_b16 v[222:223], v246 offset:8704
    s_waitcnt lgkmcnt(10)
    v_mfma_f32_32x32x16_bf16 v[144:159], v[168:171], v[8:11], v[144:159]
    ds_read_b64_tr_b16 v[164:165], v237 offset:4096
    ds_read_b64_tr_b16 v[166:167], v237 offset:4352
    s_add_u32 m0, s62, 90112
    s_add_u32 s40, s54, 737280
    buffer_load_dwordx4 v232, s[12:15], s40 offen lds
    s_waitcnt lgkmcnt(10)
    v_mfma_f32_32x32x16_bf16 v[176:191], v[208:211], v[12:15], v[176:191]
    ds_read_b64_tr_b16 v[224:225], v245 offset:10240
    ds_read_b64_tr_b16 v[226:227], v245 offset:10752
    s_waitcnt lgkmcnt(10)
    v_mfma_f32_32x32x16_bf16 v[192:207], v[212:215], v[12:15], v[192:207]
    ds_read_b64_tr_b16 v[228:229], v246 offset:10240
    ds_read_b64_tr_b16 v[230:231], v246 offset:10752
    s_waitcnt lgkmcnt(10)
    v_mfma_f32_32x32x16_bf16 v[144:159], v[160:163], v[12:15], v[144:159]
    ds_read_b64_tr_b16 v[168:169], v237 offset:5120
    ds_read_b64_tr_b16 v[170:171], v237 offset:5376
    s_add_u32 m0, s62, 98304
    s_add_u32 s40, s54, 1105920
    buffer_load_dwordx4 v232, s[12:15], s40 offen lds
    s_waitcnt lgkmcnt(10)
    v_mfma_f32_32x32x16_bf16 v[176:191], v[216:219], v[16:19], v[176:191]
    ds_read_b64_tr_b16 v[208:209], v245 offset:12288
    ds_read_b64_tr_b16 v[210:211], v245 offset:12800
    s_waitcnt lgkmcnt(10)
    v_mfma_f32_32x32x16_bf16 v[192:207], v[220:223], v[16:19], v[192:207]
    ds_read_b64_tr_b16 v[212:213], v246 offset:12288
    ds_read_b64_tr_b16 v[214:215], v246 offset:12800
    s_waitcnt lgkmcnt(10)
    v_mfma_f32_32x32x16_bf16 v[144:159], v[164:167], v[16:19], v[144:159]
    ds_read_b64_tr_b16 v[160:161], v237 offset:6144
    ds_read_b64_tr_b16 v[162:163], v237 offset:6400
    s_add_u32 m0, s62, 77824
    s_add_u32 s40, s54, 92160
    buffer_load_dwordx4 v232, s[12:15], s40 offen lds
    s_waitcnt lgkmcnt(10)
    v_mfma_f32_32x32x16_bf16 v[176:191], v[224:227], v[20:23], v[176:191]
    ds_read_b64_tr_b16 v[216:217], v245 offset:14336
    ds_read_b64_tr_b16 v[218:219], v245 offset:14848
    s_waitcnt lgkmcnt(10)
    v_mfma_f32_32x32x16_bf16 v[192:207], v[228:231], v[20:23], v[192:207]
    ds_read_b64_tr_b16 v[220:221], v246 offset:14336
    ds_read_b64_tr_b16 v[222:223], v246 offset:14848
    s_waitcnt lgkmcnt(10)
    v_mfma_f32_32x32x16_bf16 v[144:159], v[168:171], v[20:23], v[144:159]
    ds_read_b64_tr_b16 v[164:165], v237 offset:7168
    ds_read_b64_tr_b16 v[166:167], v237 offset:7424
    s_add_u32 m0, s62, 86016
    s_add_u32 s40, s54, 460800
    buffer_load_dwordx4 v232, s[12:15], s40 offen lds
    s_waitcnt lgkmcnt(10)
    v_mfma_f32_32x32x16_bf16 v[176:191], v[208:211], v[24:27], v[176:191]
    ds_read_b64_tr_b16 v[224:225], v245 offset:16384
    ds_read_b64_tr_b16 v[226:227], v245 offset:16896
    s_waitcnt lgkmcnt(10)
    v_mfma_f32_32x32x16_bf16 v[192:207], v[212:215], v[24:27], v[192:207]
    ds_read_b64_tr_b16 v[228:229], v246 offset:16384
    ds_read_b64_tr_b16 v[230:231], v246 offset:16896
    s_waitcnt lgkmcnt(10)
    v_mfma_f32_32x32x16_bf16 v[144:159], v[160:163], v[24:27], v[144:159]
    ds_read_b64_tr_b16 v[168:169], v237 offset:8192
    ds_read_b64_tr_b16 v[170:171], v237 offset:8448
    s_add_u32 m0, s62, 94208
    s_add_u32 s40, s54, 755712
    buffer_load_dwordx4 v232, s[12:15], s40 offen lds
    s_waitcnt lgkmcnt(10)
    v_mfma_f32_32x32x16_bf16 v[176:191], v[216:219], v[28:31], v[176:191]
    ds_read_b64_tr_b16 v[208:209], v245 offset:18432
    ds_read_b64_tr_b16 v[210:211], v245 offset:18944
    s_waitcnt lgkmcnt(10)
    v_mfma_f32_32x32x16_bf16 v[192:207], v[220:223], v[28:31], v[192:207]
    ds_read_b64_tr_b16 v[212:213], v246 offset:18432
    ds_read_b64_tr_b16 v[214:215], v246 offset:18944
    s_waitcnt lgkmcnt(10)
    v_mfma_f32_32x32x16_bf16 v[144:159], v[164:167], v[28:31], v[144:159]
    ds_read_b64_tr_b16 v[160:161], v237 offset:9216
    ds_read_b64_tr_b16 v[162:163], v237 offset:9472
    s_add_u32 m0, s62, 102400
    s_add_u32 s40, s54, 1124352
    buffer_load_dwordx4 v232, s[12:15], s40 offen lds
    s_waitcnt lgkmcnt(10)
    v_mfma_f32_32x32x16_bf16 v[176:191], v[224:227], v[32:35], v[176:191]
    ds_read_b64_tr_b16 v[216:217], v245 offset:20480
    ds_read_b64_tr_b16 v[218:219], v245 offset:20992
    s_waitcnt lgkmcnt(10)
    v_mfma_f32_32x32x16_bf16 v[192:207], v[228:231], v[32:35], v[192:207]
    ds_read_b64_tr_b16 v[220:221], v246 offset:20480
    ds_read_b64_tr_b16 v[222:223], v246 offset:20992
    s_waitcnt lgkmcnt(10)
    v_mfma_f32_32x32x16_bf16 v[144:159], v[168:171], v[32:35], v[144:159]
    ds_read_b64_tr_b16 v[164:165], v237 offset:10240
    ds_read_b64_tr_b16 v[166:167], v237 offset:10496
    s_add_u32 m0, s62, 106496
    s_and_b32 s40, s33, 1
    s_mul_i32 s40, s40, 36864
    s_add_u32 s40, s40, s55
    s_add_u32 s40, s40, 73728
    buffer_load_dwordx4 v234, s[12:15], s40 offen lds
    s_waitcnt lgkmcnt(10)
    v_mfma_f32_32x32x16_bf16 v[176:191], v[208:211], v[36:39], v[176:191]
    ds_read_b64_tr_b16 v[224:225], v245 offset:22528
    ds_read_b64_tr_b16 v[226:227], v245 offset:23040
    s_waitcnt lgkmcnt(10)
    v_mfma_f32_32x32x16_bf16 v[192:207], v[212:215], v[36:39], v[192:207]
    ds_read_b64_tr_b16 v[228:229], v246 offset:22528
    ds_read_b64_tr_b16 v[230:231], v246 offset:23040
    s_waitcnt lgkmcnt(10)
    v_mfma_f32_32x32x16_bf16 v[144:159], v[160:163], v[36:39], v[144:159]
    ds_read_b64_tr_b16 v[168:169], v237 offset:11264
    ds_read_b64_tr_b16 v[170:171], v237 offset:11520
    s_waitcnt lgkmcnt(0)
    s_barrier
    v_add_u32 v245, 0, v238
    v_add_u32 v246, 0, v239
    v_add_u32 v237, 0, v236
    s_waitcnt lgkmcnt(10)
    v_mfma_f32_32x32x16_bf16 v[176:191], v[216:219], v[40:43], v[176:191]
    ds_read_b64_tr_b16 v[208:209], v245 offset:0
    ds_read_b64_tr_b16 v[210:211], v245 offset:512
    s_waitcnt lgkmcnt(10)
    v_mfma_f32_32x32x16_bf16 v[192:207], v[220:223], v[40:43], v[192:207]
    ds_read_b64_tr_b16 v[212:213], v246 offset:0
    ds_read_b64_tr_b16 v[214:215], v246 offset:512
    s_waitcnt lgkmcnt(10)
    v_mfma_f32_32x32x16_bf16 v[144:159], v[164:167], v[40:43], v[144:159]
    ds_read_b64_tr_b16 v[160:161], v237 offset:0
    ds_read_b64_tr_b16 v[162:163], v237 offset:256
    s_add_u32 m0, s62, 110592
    s_add_u32 s40, s54, 110592
    buffer_load_dwordx4 v232, s[12:15], s40 offen lds
    s_waitcnt lgkmcnt(10)
    v_mfma_f32_32x32x16_bf16 v[176:191], v[224:227], v[44:47], v[176:191]
    ds_read_b64_tr_b16 v[216:217], v245 offset:2048
    ds_read_b64_tr_b16 v[218:219], v245 offset:2560
    s_waitcnt lgkmcnt(10)
    v_mfma_f32_32x32x16_bf16 v[192:207], v[228:231], v[44:47], v[192:207]
    ds_read_b64_tr_b16 v[220:221], v246 offset:2048
    ds_read_b64_tr_b16 v[222:223], v246 offset:2560
    s_waitcnt lgkmcnt(10)
    v_mfma_f32_32x32x16_bf16 v[144:159], v[168:171], v[44:47], v[144:159]
    ds_read_b64_tr_b16 v[164:165], v237 offset:1024
    ds_read_b64_tr_b16 v[166:167], v237 offset:1280
    s_add_u32 m0, s62, 118784
    s_add_u32 s40, s54, 479232
    buffer_load_dwordx4 v232, s[12:15], s40 offen lds
    s_waitcnt lgkmcnt(10)
    v_mfma_f32_32x32x16_bf16 v[176:191], v[208:211], v[48:51], v[176:191]
    ds_read_b64_tr_b16 v[224:225], v245 offset:4096
    ds_read_b64_tr_b16 v[226:227], v245 offset:4608
    s_waitcnt lgkmcnt(10)
    v_mfma_f32_32x32x16_bf16 v[192:207], v[212:215], v[48:51], v[192:207]
    ds_read_b64_tr_b16 v[228:229], v246 offset:4096
    ds_read_b64_tr_b16 v[230:231], v246 offset:4608
    s_waitcnt lgkmcnt(10)
    v_mfma_f32_32x32x16_bf16 v[144:159], v[160:163], v[48:51], v[144:159]
    ds_read_b64_tr_b16 v[168:169], v237 offset:2048
    ds_read_b64_tr_b16 v[170:171], v237 offset:2304
    s_add_u32 m0, s62, 126976
    s_add_u32 s40, s54, 774144
    buffer_load_dwordx4 v232, s[12:15], s40 offen lds
    s_waitcnt lgkmcnt(10)
    v_mfma_f32_32x32x16_bf16 v[176:191], v[216:219], v[52:55], v[176:191]
    ds_read_b64_tr_b16 v[208:209], v245 offset:6144
    ds_read_b64_tr_b16 v[210:211], v245 offset:6656
    s_waitcnt lgkmcnt(10)
    v_mfma_f32_32x32x16_bf16 v[192:207], v[220:223], v[52:55], v[192:207]
    ds_read_b64_tr_b16 v[212:213], v246 offset:6144
    ds_read_b64_tr_b16 v[214:215], v246 offset:6656
    s_waitcnt lgkmcnt(10)
    v_mfma_f32_32x32x16_bf16 v[144:159], v[164:167], v[52:55], v[144:159]
    ds_read_b64_tr_b16 v[160:161], v237 offset:3072
    ds_read_b64_tr_b16 v[162:163], v237 offset:3328
    s_add_u32 m0, s62, 135168
    s_add_u32 s40, s54, 1142784
    buffer_load_dwordx4 v232, s[12:15], s40 offen lds
    s_waitcnt lgkmcnt(10)
    v_mfma_f32_32x32x16_bf16 v[176:191], v[224:227], v[56:59], v[176:191]
    ds_read_b64_tr_b16 v[216:217], v245 offset:8192
    ds_read_b64_tr_b16 v[218:219], v245 offset:8704
    s_waitcnt lgkmcnt(10)
    v_mfma_f32_32x32x16_bf16 v[192:207], v[228:231], v[56:59], v[192:207]
    ds_read_b64_tr_b16 v[220:221], v246 offset:8192
    ds_read_b64_tr_b16 v[222:223], v246 offset:8704
    s_waitcnt lgkmcnt(10)
    v_mfma_f32_32x32x16_bf16 v[144:159], v[168:171], v[56:59], v[144:159]
    ds_read_b64_tr_b16 v[164:165], v237 offset:4096
    ds_read_b64_tr_b16 v[166:167], v237 offset:4352
    s_add_u32 m0, s62, 114688
    s_add_u32 s40, s54, 129024
    buffer_load_dwordx4 v232, s[12:15], s40 offen lds
    s_waitcnt lgkmcnt(10)
    v_mfma_f32_32x32x16_bf16 v[176:191], v[208:211], v[60:63], v[176:191]
    ds_read_b64_tr_b16 v[224:225], v245 offset:10240
    ds_read_b64_tr_b16 v[226:227], v245 offset:10752
    s_waitcnt lgkmcnt(10)
    v_mfma_f32_32x32x16_bf16 v[192:207], v[212:215], v[60:63], v[192:207]
    ds_read_b64_tr_b16 v[228:229], v246 offset:10240
    ds_read_b64_tr_b16 v[230:231], v246 offset:10752
    s_waitcnt lgkmcnt(10)
    v_mfma_f32_32x32x16_bf16 v[144:159], v[160:163], v[60:63], v[144:159]
    ds_read_b64_tr_b16 v[168:169], v237 offset:5120
    ds_read_b64_tr_b16 v[170:171], v237 offset:5376
    s_add_u32 m0, s62, 122880
    s_add_u32 s40, s54, 497664
    buffer_load_dwordx4 v232, s[12:15], s40 offen lds
    s_waitcnt lgkmcnt(10)
    v_mfma_f32_32x32x16_bf16 v[176:191], v[216:219], v[64:67], v[176:191]
    ds_read_b64_tr_b16 v[208:209], v245 offset:12288
    ds_read_b64_tr_b16 v[210:211], v245 offset:12800
    s_waitcnt lgkmcnt(10)
    v_mfma_f32_32x32x16_bf16 v[192:207], v[220:223], v[64:67], v[192:207]
    ds_read_b64_tr_b16 v[212:213], v246 offset:12288
    ds_read_b64_tr_b16 v[214:215], v246 offset:12800
    s_waitcnt lgkmcnt(10)
    v_mfma_f32_32x32x16_bf16 v[144:159], v[164:167], v[64:67], v[144:159]
    ds_read_b64_tr_b16 v[160:161], v237 offset:6144
    ds_read_b64_tr_b16 v[162:163], v237 offset:6400
    s_add_u32 m0, s62, 131072
    s_add_u32 s40, s54, 792576
    buffer_load_dwordx4 v232, s[12:15], s40 offen lds
    s_waitcnt lgkmcnt(10)
    v_mfma_f32_32x32x16_bf16 v[176:191], v[224:227], v[68:71], v[176:191]
    ds_read_b64_tr_b16 v[216:217], v245 offset:14336
    ds_read_b64_tr_b16 v[218:219], v245 offset:14848
    s_waitcnt lgkmcnt(10)
    v_mfma_f32_32x32x16_bf16 v[192:207], v[228:231], v[68:71], v[192:207]
    ds_read_b64_tr_b16 v[220:221], v246 offset:14336
    ds_read_b64_tr_b16 v[222:223], v246 offset:14848
    s_waitcnt lgkmcnt(10)
    v_mfma_f32_32x32x16_bf16 v[144:159], v[168:171], v[68:71], v[144:159]
    ds_read_b64_tr_b16 v[164:165], v237 offset:7168
    ds_read_b64_tr_b16 v[166:167], v237 offset:7424
    s_add_u32 m0, s62, 139264
    s_add_u32 s40, s54, 1161216
    buffer_load_dwordx4 v232, s[12:15], s40 offen lds
    s_waitcnt lgkmcnt(10)
    v_mfma_f32_32x32x16_bf16 v[176:191], v[208:211], v[72:75], v[176:191]
    ds_read_b64_tr_b16 v[224:225], v245 offset:16384
    ds_read_b64_tr_b16 v[226:227], v245 offset:16896
    s_waitcnt lgkmcnt(10)
    v_mfma_f32_32x32x16_bf16 v[192:207], v[212:215], v[72:75], v[192:207]
    ds_read_b64_tr_b16 v[228:229], v246 offset:16384
    ds_read_b64_tr_b16 v[230:231], v246 offset:16896
    s_waitcnt lgkmcnt(10)
    v_mfma_f32_32x32x16_bf16 v[144:159], v[160:163], v[72:75], v[144:159]
    ds_read_b64_tr_b16 v[168:169], v237 offset:8192
    ds_read_b64_tr_b16 v[170:171], v237 offset:8448
    s_add_u32 m0, s62, 143360
    s_and_b32 s40, s33, 1
    s_mul_i32 s40, s40, 36864
    s_add_u32 s40, s40, s55
    s_add_u32 s40, s40, 110592
    buffer_load_dwordx4 v234, s[12:15], s40 offen lds
    s_waitcnt lgkmcnt(10)
    v_mfma_f32_32x32x16_bf16 v[176:191], v[216:219], v[76:79], v[176:191]
    ds_read_b64_tr_b16 v[208:209], v245 offset:18432
    ds_read_b64_tr_b16 v[210:211], v245 offset:18944
    s_waitcnt lgkmcnt(10)
    v_mfma_f32_32x32x16_bf16 v[192:207], v[220:223], v[76:79], v[192:207]
    ds_read_b64_tr_b16 v[212:213], v246 offset:18432
    ds_read_b64_tr_b16 v[214:215], v246 offset:18944
    s_waitcnt lgkmcnt(10)
    v_mfma_f32_32x32x16_bf16 v[144:159], v[164:167], v[76:79], v[144:159]
    ds_read_b64_tr_b16 v[160:161], v237 offset:9216
    ds_read_b64_tr_b16 v[162:163], v237 offset:9472
    s_waitcnt lgkmcnt(10)
    v_mfma_f32_32x32x16_bf16 v[176:191], v[224:227], v[80:83], v[176:191]
    ds_read_b64_tr_b16 v[216:217], v245 offset:20480
    ds_read_b64_tr_b16 v[218:219], v245 offset:20992
    s_waitcnt lgkmcnt(10)
    v_mfma_f32_32x32x16_bf16 v[192:207], v[228:231], v[80:83], v[192:207]
    ds_read_b64_tr_b16 v[220:221], v246 offset:20480
    ds_read_b64_tr_b16 v[222:223], v246 offset:20992
    s_waitcnt lgkmcnt(10)
    v_mfma_f32_32x32x16_bf16 v[144:159], v[168:171], v[80:83], v[144:159]
    ds_read_b64_tr_b16 v[164:165], v237 offset:10240
    ds_read_b64_tr_b16 v[166:167], v237 offset:10496
    s_waitcnt lgkmcnt(10)
    v_mfma_f32_32x32x16_bf16 v[176:191], v[208:211], v[84:87], v[176:191]
    ds_read_b64_tr_b16 v[224:225], v245 offset:22528
    ds_read_b64_tr_b16 v[226:227], v245 offset:23040
    s_waitcnt lgkmcnt(10)
    v_mfma_f32_32x32x16_bf16 v[192:207], v[212:215], v[84:87], v[192:207]
    ds_read_b64_tr_b16 v[228:229], v246 offset:22528
    ds_read_b64_tr_b16 v[230:231], v246 offset:23040
    s_waitcnt lgkmcnt(10)
    v_mfma_f32_32x32x16_bf16 v[144:159], v[160:163], v[84:87], v[144:159]
    ds_read_b64_tr_b16 v[168:169], v237 offset:11264
    ds_read_b64_tr_b16 v[170:171], v237 offset:11520
    s_waitcnt vmcnt(9) lgkmcnt(0)
    s_barrier
    v_add_u32 v245, 36864, v238
    v_add_u32 v246, 36864, v239
    v_add_u32 v237, 36864, v236
    s_waitcnt lgkmcnt(10)
    v_mfma_f32_32x32x16_bf16 v[176:191], v[216:219], v[88:91], v[176:191]
    ds_read_b64_tr_b16 v[208:209], v245 offset:0
    ds_read_b64_tr_b16 v[210:211], v245 offset:512
    s_waitcnt lgkmcnt(10)
    v_mfma_f32_32x32x16_bf16 v[192:207], v[220:223], v[88:91], v[192:207]
    ds_read_b64_tr_b16 v[212:213], v246 offset:0
    ds_read_b64_tr_b16 v[214:215], v246 offset:512
    s_waitcnt lgkmcnt(10)
    v_mfma_f32_32x32x16_bf16 v[144:159], v[164:167], v[88:91], v[144:159]
    ds_read_b64_tr_b16 v[160:161], v237 offset:0
    ds_read_b64_tr_b16 v[162:163], v237 offset:256
    s_add_u32 m0, s62, 0
    s_add_u32 s40, s54, 0
    buffer_load_dwordx4 v232, s[12:15], s40 offen lds
    s_waitcnt lgkmcnt(10)
    v_mfma_f32_32x32x16_bf16 v[176:191], v[224:227], v[92:95], v[176:191]
    ds_read_b64_tr_b16 v[216:217], v245 offset:2048
    ds_read_b64_tr_b16 v[218:219], v245 offset:2560
    s_waitcnt lgkmcnt(10)
    v_mfma_f32_32x32x16_bf16 v[192:207], v[228:231], v[92:95], v[192:207]
    ds_read_b64_tr_b16 v[220:221], v246 offset:2048
    ds_read_b64_tr_b16 v[222:223], v246 offset:2560
    s_waitcnt lgkmcnt(10)
    v_mfma_f32_32x32x16_bf16 v[144:159], v[168:171], v[92:95], v[144:159]
    ds_read_b64_tr_b16 v[164:165], v237 offset:1024
    ds_read_b64_tr_b16 v[166:167], v237 offset:1280
    s_add_u32 m0, s62, 8192
    s_add_u32 s40, s54, 368640
    buffer_load_dwordx4 v232, s[12:15], s40 offen lds
    s_waitcnt lgkmcnt(10)
    v_mfma_f32_32x32x16_bf16 v[176:191], v[208:211], v[96:99], v[176:191]
    ds_read_b64_tr_b16 v[224:225], v245 offset:4096
    ds_read_b64_tr_b16 v[226:227], v245 offset:4608
    s_waitcnt lgkmcnt(10)
    v_mfma_f32_32x32x16_bf16 v[192:207], v[212:215], v[96:99], v[192:207]
    ds_read_b64_tr_b16 v[228:229], v246 offset:4096
    ds_read_b64_tr_b16 v[230:231], v246 offset:4608
    s_waitcnt lgkmcnt(10)
    v_mfma_f32_32x32x16_bf16 v[144:159], v[160:163], v[96:99], v[144:159]
    ds_read_b64_tr_b16 v[168:169], v237 offset:2048
    ds_read_b64_tr_b16 v[170:171], v237 offset:2304
    s_add_u32 m0, s62, 16384
    s_add_u32 s40, s54, 663552
    buffer_load_dwordx4 v232, s[12:15], s40 offen lds
    s_waitcnt lgkmcnt(10)
    v_mfma_f32_32x32x16_bf16 v[176:191], v[216:219], v[100:103], v[176:191]
    ds_read_b64_tr_b16 v[208:209], v245 offset:6144
    ds_read_b64_tr_b16 v[210:211], v245 offset:6656
    s_waitcnt lgkmcnt(10)
    v_mfma_f32_32x32x16_bf16 v[192:207], v[220:223], v[100:103], v[192:207]
    ds_read_b64_tr_b16 v[212:213], v246 offset:6144
    ds_read_b64_tr_b16 v[214:215], v246 offset:6656
    s_waitcnt lgkmcnt(10)
    v_mfma_f32_32x32x16_bf16 v[144:159], v[164:167], v[100:103], v[144:159]
    ds_read_b64_tr_b16 v[160:161], v237 offset:3072
    ds_read_b64_tr_b16 v[162:163], v237 offset:3328
    s_add_u32 m0, s62, 24576
    s_add_u32 s40, s54, 1032192
    buffer_load_dwordx4 v232, s[12:15], s40 offen lds
    s_waitcnt lgkmcnt(10)
    v_mfma_f32_32x32x16_bf16 v[176:191], v[224:227], v[104:107], v[176:191]
    ds_read_b64_tr_b16 v[216:217], v245 offset:8192
    ds_read_b64_tr_b16 v[218:219], v245 offset:8704
    s_waitcnt lgkmcnt(10)
    v_mfma_f32_32x32x16_bf16 v[192:207], v[228:231], v[104:107], v[192:207]
    ds_read_b64_tr_b16 v[220:221], v246 offset:8192
    ds_read_b64_tr_b16 v[222:223], v246 offset:8704
    s_waitcnt lgkmcnt(10)
    v_mfma_f32_32x32x16_bf16 v[144:159], v[168:171], v[104:107], v[144:159]
    ds_read_b64_tr_b16 v[164:165], v237 offset:4096
    ds_read_b64_tr_b16 v[166:167], v237 offset:4352
    s_add_u32 m0, s62, 4096
    s_add_u32 s40, s54, 18432
    buffer_load_dwordx4 v232, s[12:15], s40 offen lds
    s_waitcnt lgkmcnt(10)
    v_mfma_f32_32x32x16_bf16 v[176:191], v[208:211], v[108:111], v[176:191]
    ds_read_b64_tr_b16 v[224:225], v245 offset:10240
    ds_read_b64_tr_b16 v[226:227], v245 offset:10752
    s_waitcnt lgkmcnt(10)
    v_mfma_f32_32x32x16_bf16 v[192:207], v[212:215], v[108:111], v[192:207]
    ds_read_b64_tr_b16 v[228:229], v246 offset:10240
    ds_read_b64_tr_b16 v[230:231], v246 offset:10752
    s_waitcnt lgkmcnt(10)
    v_mfma_f32_32x32x16_bf16 v[144:159], v[160:163], v[108:111], v[144:159]
    ds_read_b64_tr_b16 v[168:169], v237 offset:5120
    ds_read_b64_tr_b16 v[170:171], v237 offset:5376
    s_add_u32 m0, s62, 12288
    s_add_u32 s40, s54, 387072
    buffer_load_dwordx4 v232, s[12:15], s40 offen lds
    s_waitcnt lgkmcnt(10)
    v_mfma_f32_32x32x16_bf16 v[176:191], v[216:219], v[112:115], v[176:191]
    ds_read_b64_tr_b16 v[208:209], v245 offset:12288
    ds_read_b64_tr_b16 v[210:211], v245 offset:12800
    s_waitcnt lgkmcnt(10)
    v_mfma_f32_32x32x16_bf16 v[192:207], v[220:223], v[112:115], v[192:207]
    ds_read_b64_tr_b16 v[212:213], v246 offset:12288
    ds_read_b64_tr_b16 v[214:215], v246 offset:12800
    s_waitcnt lgkmcnt(10)
    v_mfma_f32_32x32x16_bf16 v[144:159], v[164:167], v[112:115], v[144:159]
    ds_read_b64_tr_b16 v[160:161], v237 offset:6144
    ds_read_b64_tr_b16 v[162:163], v237 offset:6400
    s_add_u32 m0, s62, 20480
    s_add_u32 s40, s54, 681984
    buffer_load_dwordx4 v232, s[12:15], s40 offen lds
    s_waitcnt lgkmcnt(10)
    v_mfma_f32_32x32x16_bf16 v[176:191], v[224:227], v[116:119], v[176:191]
    ds_read_b64_tr_b16 v[216:217], v245 offset:14336
    ds_read_b64_tr_b16 v[218:219], v245 offset:14848
    s_waitcnt lgkmcnt(10)
    v_mfma_f32_32x32x16_bf16 v[192:207], v[228:231], v[116:119], v[192:207]
    ds_read_b64_tr_b16 v[220:221], v246 offset:14336
    ds_read_b64_tr_b16 v[222:223], v246 offset:14848
    s_waitcnt lgkmcnt(10)
    v_mfma_f32_32x32x16_bf16 v[144:159], v[168:171], v[116:119], v[144:159]
    ds_read_b64_tr_b16 v[164:165], v237 offset:7168
    ds_read_b64_tr_b16 v[166:167], v237 offset:7424
    s_add_u32 m0, s62, 28672
    s_add_u32 s40, s54, 1050624
    buffer_load_dwordx4 v232, s[12:15], s40 offen lds
    s_waitcnt lgkmcnt(10)
    v_mfma_f32_32x32x16_bf16 v[176:191], v[208:211], v[120:123], v[176:191]
    ds_read_b64_tr_b16 v[224:225], v245 offset:16384
    ds_read_b64_tr_b16 v[226:227], v245 offset:16896
    s_waitcnt lgkmcnt(10)
    v_mfma_f32_32x32x16_bf16 v[192:207], v[212:215], v[120:123], v[192:207]
    ds_read_b64_tr_b16 v[228:229], v246 offset:16384
    ds_read_b64_tr_b16 v[230:231], v246 offset:16896
    s_waitcnt lgkmcnt(10)
    v_mfma_f32_32x32x16_bf16 v[144:159], v[160:163], v[120:123], v[144:159]
    ds_read_b64_tr_b16 v[168:169], v237 offset:8192
    ds_read_b64_tr_b16 v[170:171], v237 offset:8448
    s_add_u32 m0, s62, 32768
    s_and_b32 s40, s33, 1
    s_mul_i32 s40, s40, 36864
    s_add_u32 s40, s40, s55
    s_add_u32 s40, s40, 0
    buffer_load_dwordx4 v234, s[12:15], s40 offen lds
    s_waitcnt lgkmcnt(10)
    v_mfma_f32_32x32x16_bf16 v[176:191], v[216:219], v[124:127], v[176:191]
    ds_read_b64_tr_b16 v[208:209], v245 offset:18432
    ds_read_b64_tr_b16 v[210:211], v245 offset:18944
    s_waitcnt lgkmcnt(10)
    v_mfma_f32_32x32x16_bf16 v[192:207], v[220:223], v[124:127], v[192:207]
    ds_read_b64_tr_b16 v[212:213], v246 offset:18432
    ds_read_b64_tr_b16 v[214:215], v246 offset:18944
    s_waitcnt lgkmcnt(10)
    v_mfma_f32_32x32x16_bf16 v[144:159], v[164:167], v[124:127], v[144:159]
    ds_read_b64_tr_b16 v[160:161], v237 offset:9216
    ds_read_b64_tr_b16 v[162:163], v237 offset:9472
    s_waitcnt lgkmcnt(10)
    v_mfma_f32_32x32x16_bf16 v[176:191], v[224:227], v[128:131], v[176:191]
    ds_read_b64_tr_b16 v[216:217], v245 offset:20480
    ds_read_b64_tr_b16 v[218:219], v245 offset:20992
    s_waitcnt lgkmcnt(10)
    v_mfma_f32_32x32x16_bf16 v[192:207], v[228:231], v[128:131], v[192:207]
    ds_read_b64_tr_b16 v[220:221], v246 offset:20480
    ds_read_b64_tr_b16 v[222:223], v246 offset:20992
    s_waitcnt lgkmcnt(10)
    v_mfma_f32_32x32x16_bf16 v[144:159], v[168:171], v[128:131], v[144:159]
    ds_read_b64_tr_b16 v[164:165], v237 offset:10240
    ds_read_b64_tr_b16 v[166:167], v237 offset:10496
    s_waitcnt lgkmcnt(10)
    v_mfma_f32_32x32x16_bf16 v[176:191], v[208:211], v[132:135], v[176:191]
    ds_read_b64_tr_b16 v[224:225], v245 offset:22528
    ds_read_b64_tr_b16 v[226:227], v245 offset:23040
    s_waitcnt lgkmcnt(10)
    v_mfma_f32_32x32x16_bf16 v[192:207], v[212:215], v[132:135], v[192:207]
    ds_read_b64_tr_b16 v[228:229], v246 offset:22528
    ds_read_b64_tr_b16 v[230:231], v246 offset:23040
    s_waitcnt lgkmcnt(10)
    v_mfma_f32_32x32x16_bf16 v[144:159], v[160:163], v[132:135], v[144:159]
    ds_read_b64_tr_b16 v[168:169], v237 offset:11264
    ds_read_b64_tr_b16 v[170:171], v237 offset:11520
    s_waitcnt vmcnt(9) lgkmcnt(0)
    s_barrier
    s_waitcnt lgkmcnt(10)
    v_mfma_f32_32x32x16_bf16 v[176:191], v[216:219], v[136:139], v[176:191]
    s_waitcnt lgkmcnt(8)
    v_mfma_f32_32x32x16_bf16 v[192:207], v[220:223], v[136:139], v[192:207]
    s_waitcnt lgkmcnt(6)
    v_mfma_f32_32x32x16_bf16 v[144:159], v[164:167], v[136:139], v[144:159]
    s_waitcnt lgkmcnt(4)
    v_mfma_f32_32x32x16_bf16 v[176:191], v[224:227], v[140:143], v[176:191]
    s_waitcnt lgkmcnt(2)
    v_mfma_f32_32x32x16_bf16 v[192:207], v[228:231], v[140:143], v[192:207]
    s_waitcnt lgkmcnt(0)
    v_mfma_f32_32x32x16_bf16 v[144:159], v[168:171], v[140:143], v[144:159]
    v_lshlrev_b32 v165, 4, v243
    v_lshlrev_b32 v164, 2, v243
    v_bfe_u32 v169, v243, 4, 1
    v_bfe_u32 v170, v243, 2, 2
    v_lshl_add_u32 v169, v169, 2, v170
    v_lshrrev_b32 v168, 5, v243
    v_lshl_add_u32 v168, v168, 4, v169
    v_and_b32 v170, 3, v243
    v_lshlrev_b32 v170, 3, v170
    v_lshl_add_u32 v160, v168, 8, v170
    v_lshl_add_u32 v160, v169, 5, v160
    s_lshl_b32 s48, s34, 14
    v_add_u32 v160, s48, v160
    v_lshl_add_u32 v166, v168, 5, v170
    s_lshl_b32 s48, s34, 11
    s_add_u32 s48, s48, 32768
    v_add_u32 v166, s48, v166
    buffer_load_dword v163, v164, s[20:23], s60 offen sc1
    s_add_u32 m0, s62, 40960
    s_add_u32 s40, s54, 55296
    buffer_load_dwordx4 v232, s[12:15], s40 offen lds
    v_mul_f32 v248, s51, v176
    v_mul_f32 v249, s51, v177
    v_mul_f32 v250, s51, v178
    v_mul_f32 v251, s51, v179
    v_exp_f32 v248, v248
    v_exp_f32 v249, v249
    v_exp_f32 v250, v250
    v_exp_f32 v251, v251
    v_add_f32 v248, 1.0, v248
    v_add_f32 v249, 1.0, v249
    v_add_f32 v250, 1.0, v250
    v_add_f32 v251, 1.0, v251
    v_rcp_f32 v248, v248
    v_rcp_f32 v249, v249
    v_rcp_f32 v250, v250
    v_rcp_f32 v251, v251
    v_mul_f32 v248, v176, v248
    v_mul_f32 v249, v177, v249
    v_mul_f32 v250, v178, v250
    v_mul_f32 v251, v179, v251
    v_cvt_pk_bf16_f32 v208, v248, v249
    v_cvt_pk_bf16_f32 v209, v250, v251
    s_add_u32 m0, s62, 49152
    s_add_u32 s40, s54, 423936
    buffer_load_dwordx4 v232, s[12:15], s40 offen lds
    s_add_u32 m0, s62, 57344
    s_add_u32 s40, s54, 718848
    buffer_load_dwordx4 v232, s[12:15], s40 offen lds
    v_mul_f32 v248, s51, v180
    v_mul_f32 v249, s51, v181
    v_mul_f32 v250, s51, v182
    v_mul_f32 v251, s51, v183
    v_exp_f32 v248, v248
    v_exp_f32 v249, v249
    v_exp_f32 v250, v250
    v_exp_f32 v251, v251
    v_add_f32 v248, 1.0, v248
    v_add_f32 v249, 1.0, v249
    v_add_f32 v250, 1.0, v250
    v_add_f32 v251, 1.0, v251
    v_rcp_f32 v248, v248
    v_rcp_f32 v249, v249
    v_rcp_f32 v250, v250
    v_rcp_f32 v251, v251
    v_mul_f32 v248, v180, v248
    v_mul_f32 v249, v181, v249
    v_mul_f32 v250, v182, v250
    v_mul_f32 v251, v183, v251
    v_cvt_pk_bf16_f32 v210, v248, v249
    v_cvt_pk_bf16_f32 v211, v250, v251
    s_add_u32 s38, s46, 12288
    buffer_store_dwordx4 v[208:211], v244, s[20:23], s38 offen offset:0 sc1
    s_add_u32 m0, s62, 65536
    s_add_u32 s40, s54, 1087488
    buffer_load_dwordx4 v232, s[12:15], s40 offen lds
    v_mul_f32 v248, s51, v184
    v_mul_f32 v249, s51, v185
    v_mul_f32 v250, s51, v186
    v_mul_f32 v251, s51, v187
    v_exp_f32 v248, v248
    v_exp_f32 v249, v249
    v_exp_f32 v250, v250
    v_exp_f32 v251, v251
    v_add_f32 v248, 1.0, v248
    v_add_f32 v249, 1.0, v249
    v_add_f32 v250, 1.0, v250
    v_add_f32 v251, 1.0, v251
    v_rcp_f32 v248, v248
    v_rcp_f32 v249, v249
    v_rcp_f32 v250, v250
    v_rcp_f32 v251, v251
    v_mul_f32 v248, v184, v248
    v_mul_f32 v249, v185, v249
    v_mul_f32 v250, v186, v250
    v_mul_f32 v251, v187, v251
    v_cvt_pk_bf16_f32 v212, v248, v249
    v_cvt_pk_bf16_f32 v213, v250, v251
    v_mul_f32 v248, s51, v188
    v_mul_f32 v249, s51, v189
    v_mul_f32 v250, s51, v190
    v_mul_f32 v251, s51, v191
    v_exp_f32 v248, v248
    v_exp_f32 v249, v249
    v_exp_f32 v250, v250
    v_exp_f32 v251, v251
    v_add_f32 v248, 1.0, v248
    v_add_f32 v249, 1.0, v249
    v_add_f32 v250, 1.0, v250
    v_add_f32 v251, 1.0, v251
    v_rcp_f32 v248, v248
    v_rcp_f32 v249, v249
    v_rcp_f32 v250, v250
    v_rcp_f32 v251, v251
    v_mul_f32 v248, v188, v248
    v_mul_f32 v249, v189, v249
    v_mul_f32 v250, v190, v250
    v_mul_f32 v251, v191, v251
    v_cvt_pk_bf16_f32 v214, v248, v249
    v_cvt_pk_bf16_f32 v215, v250, v251
    buffer_store_dwordx4 v[212:215], v244, s[20:23], s38 offen offset:512 sc1
    v_mul_f32 v248, s51, v192
    v_mul_f32 v249, s51, v193
    v_mul_f32 v250, s51, v194
    v_mul_f32 v251, s51, v195
    v_exp_f32 v248, v248
    v_exp_f32 v249, v249
    v_exp_f32 v250, v250
    v_exp_f32 v251, v251
    v_add_f32 v248, 1.0, v248
    v_add_f32 v249, 1.0, v249
    v_add_f32 v250, 1.0, v250
    v_add_f32 v251, 1.0, v251
    v_rcp_f32 v248, v248
    v_rcp_f32 v249, v249
    v_rcp_f32 v250, v250
    v_rcp_f32 v251, v251
    v_mul_f32 v248, v192, v248
    v_mul_f32 v249, v193, v249
    v_mul_f32 v250, v194, v250
    v_mul_f32 v251, v195, v251
    v_cvt_pk_bf16_f32 v216, v248, v249
    v_cvt_pk_bf16_f32 v217, v250, v251
    v_mul_f32 v248, s51, v196
    v_mul_f32 v249, s51, v197
    v_mul_f32 v250, s51, v198
    v_mul_f32 v251, s51, v199
    v_exp_f32 v248, v248
    v_exp_f32 v249, v249
    v_exp_f32 v250, v250
    v_exp_f32 v251, v251
    v_add_f32 v248, 1.0, v248
    v_add_f32 v249, 1.0, v249
    v_add_f32 v250, 1.0, v250
    v_add_f32 v251, 1.0, v251
    v_rcp_f32 v248, v248
    v_rcp_f32 v249, v249
    v_rcp_f32 v250, v250
    v_rcp_f32 v251, v251
    v_mul_f32 v248, v196, v248
    v_mul_f32 v249, v197, v249
    v_mul_f32 v250, v198, v250
    v_mul_f32 v251, v199, v251
    v_cvt_pk_bf16_f32 v218, v248, v249
    v_cvt_pk_bf16_f32 v219, v250, v251
    s_add_u32 s38, s46, 14336
    buffer_store_dwordx4 v[216:219], v244, s[20:23], s38 offen offset:0 sc1
    v_mul_f32 v248, s51, v200
    v_mul_f32 v249, s51, v201
    v_mul_f32 v250, s51, v202
    v_mul_f32 v251, s51, v203
    v_exp_f32 v248, v248
    v_exp_f32 v249, v249
    v_exp_f32 v250, v250
    v_exp_f32 v251, v251
    v_add_f32 v248, 1.0, v248
    v_add_f32 v249, 1.0, v249
    v_add_f32 v250, 1.0, v250
    v_add_f32 v251, 1.0, v251
    v_rcp_f32 v248, v248
    v_rcp_f32 v249, v249
    v_rcp_f32 v250, v250
    v_rcp_f32 v251, v251
    v_mul_f32 v248, v200, v248
    v_mul_f32 v249, v201, v249
    v_mul_f32 v250, v202, v250
    v_mul_f32 v251, v203, v251
    v_cvt_pk_bf16_f32 v220, v248, v249
    v_cvt_pk_bf16_f32 v221, v250, v251
    v_mul_f32 v248, s51, v204
    v_mul_f32 v249, s51, v205
    v_mul_f32 v250, s51, v206
    v_mul_f32 v251, s51, v207
    v_exp_f32 v248, v248
    v_exp_f32 v249, v249
    v_exp_f32 v250, v250
    v_exp_f32 v251, v251
    v_add_f32 v248, 1.0, v248
    v_add_f32 v249, 1.0, v249
    v_add_f32 v250, 1.0, v250
    v_add_f32 v251, 1.0, v251
    v_rcp_f32 v248, v248
    v_rcp_f32 v249, v249
    v_rcp_f32 v250, v250
    v_rcp_f32 v251, v251
    v_mul_f32 v248, v204, v248
    v_mul_f32 v249, v205, v249
    v_mul_f32 v250, v206, v250
    v_mul_f32 v251, v207, v251
    v_cvt_pk_bf16_f32 v222, v248, v249
    v_cvt_pk_bf16_f32 v223, v250, v251
    buffer_store_dwordx4 v[220:223], v244, s[20:23], s38 offen offset:512 sc1
    s_waitcnt vmcnt(8)
    s_barrier
    v_cmp_ne_u32 vcc, s35, v163
    s_and_b32 s38, vcc_lo, 0xff00ff
    s_cbranch_scc0 L_ok_2
    s_mov_b32 s61, 0
L_spin_2:
    buffer_load_dword v163, v164, s[20:23], s60 offen sc1
    s_add_u32 s61, s61, 1
    s_cmp_gt_u32 s61, 200000
    s_cbranch_scc1 L_ok_2
    s_waitcnt vmcnt(0)
    v_cmp_ne_u32 vcc, s35, v163
    s_and_b32 s38, vcc_lo, 0xff00ff
    s_cbranch_scc1 L_spin_2
L_ok_2:
    s_add_u32 s48, s53, 2048
    buffer_load_dwordx4 v[96:99], v165, s[20:23], s48 offen sc1
    buffer_load_dwordx4 v[100:103], v165, s[20:23], s48 offen offset:1024 sc1
    s_add_u32 s49, s48, 18432
    buffer_load_dwordx4 v[104:107], v165, s[20:23], s49 offen sc1
    v_mul_f32 v248, s51, v144
    v_mul_f32 v249, s51, v145
    v_mul_f32 v250, s51, v146
    v_mul_f32 v251, s51, v147
    v_exp_f32 v248, v248
    v_exp_f32 v249, v249
    v_exp_f32 v250, v250
    v_exp_f32 v251, v251
    v_add_f32 v248, 1.0, v248
    v_add_f32 v249, 1.0, v249
    v_add_f32 v250, 1.0, v250
    v_add_f32 v251, 1.0, v251
    v_rcp_f32 v248, v248
    v_rcp_f32 v249, v249
    v_rcp_f32 v250, v250
    v_rcp_f32 v251, v251
    v_mul_f32 v248, v144, v248
    v_mul_f32 v249, v145, v249
    v_mul_f32 v250, v146, v250
    v_mul_f32 v251, v147, v251
    v_cvt_pk_bf16_f32 v224, v248, v249
    v_cvt_pk_bf16_f32 v225, v250, v251
    buffer_load_dwordx4 v[108:111], v165, s[20:23], s49 offen offset:1024 sc1
    s_add_u32 m0, s62, 77824
    s_add_u32 s40, s54, 165888
    buffer_load_dwordx4 v232, s[12:15], s40 offen lds
    s_add_u32 m0, s62, 86016
    s_add_u32 s40, s54, 534528
    buffer_load_dwordx4 v232, s[12:15], s40 offen lds
    v_mul_f32 v248, s51, v148
    v_mul_f32 v249, s51, v149
    v_mul_f32 v250, s51, v150
    v_mul_f32 v251, s51, v151
    v_exp_f32 v248, v248
    v_exp_f32 v249, v249
    v_exp_f32 v250, v250
    v_exp_f32 v251, v251
    v_add_f32 v248, 1.0, v248
    v_add_f32 v249, 1.0, v249
    v_add_f32 v250, 1.0, v250
    v_add_f32 v251, 1.0, v251
    v_rcp_f32 v248, v248
    v_rcp_f32 v249, v249
    v_rcp_f32 v250, v250
    v_rcp_f32 v251, v251
    v_mul_f32 v248, v148, v248
    v_mul_f32 v249, v149, v249
    v_mul_f32 v250, v150, v250
    v_mul_f32 v251, v151, v251
    v_cvt_pk_bf16_f32 v226, v248, v249
    v_cvt_pk_bf16_f32 v227, v250, v251
    s_add_u32 s38, s46, 16384
    buffer_store_dwordx4 v[224:227], v244, s[20:23], s38 offen offset:0 sc1
    s_add_u32 m0, s62, 94208
    s_add_u32 s40, s54, 829440
    buffer_load_dwordx4 v232, s[12:15], s40 offen lds
    s_add_u32 m0, s62, 102400
    s_add_u32 s40, s54, 1198080
    buffer_load_dwordx4 v232, s[12:15], s40 offen lds
    s_add_u32 s48, s53, 8192
    buffer_load_dwordx4 v[112:115], v165, s[20:23], s48 offen sc1
    v_mul_f32 v248, s51, v152
    v_mul_f32 v249, s51, v153
    v_mul_f32 v250, s51, v154
    v_mul_f32 v251, s51, v155
    v_exp_f32 v248, v248
    v_exp_f32 v249, v249
    v_exp_f32 v250, v250
    v_exp_f32 v251, v251
    v_add_f32 v248, 1.0, v248
    v_add_f32 v249, 1.0, v249
    v_add_f32 v250, 1.0, v250
    v_add_f32 v251, 1.0, v251
    v_rcp_f32 v248, v248
    v_rcp_f32 v249, v249
    v_rcp_f32 v250, v250
    v_rcp_f32 v251, v251
    v_mul_f32 v248, v152, v248
    v_mul_f32 v249, v153, v249
    v_mul_f32 v250, v154, v250
    v_mul_f32 v251, v155, v251
    v_cvt_pk_bf16_f32 v228, v248, v249
    v_cvt_pk_bf16_f32 v229, v250, v251
    buffer_load_dwordx4 v[116:119], v165, s[20:23], s48 offen offset:1024 sc1
    s_add_u32 s49, s48, 18432
    buffer_load_dwordx4 v[120:123], v165, s[20:23], s49 offen sc1
    buffer_load_dwordx4 v[124:127], v165, s[20:23], s49 offen offset:1024 sc1
    v_mul_f32 v248, s51, v156
    v_mul_f32 v249, s51, v157
    v_mul_f32 v250, s51, v158
    v_mul_f32 v251, s51, v159
    v_exp_f32 v248, v248
    v_exp_f32 v249, v249
    v_exp_f32 v250, v250
    v_exp_f32 v251, v251
    v_add_f32 v248, 1.0, v248
    v_add_f32 v249, 1.0, v249
    v_add_f32 v250, 1.0, v250
    v_add_f32 v251, 1.0, v251
    v_rcp_f32 v248, v248
    v_rcp_f32 v249, v249
    v_rcp_f32 v250, v250
    v_rcp_f32 v251, v251
    v_mul_f32 v248, v156, v248
    v_mul_f32 v249, v157, v249
    v_mul_f32 v250, v158, v250
    v_mul_f32 v251, v159, v251
    v_cvt_pk_bf16_f32 v230, v248, v249
    v_cvt_pk_bf16_f32 v231, v250, v251
    buffer_store_dwordx4 v[228:231], v244, s[20:23], s38 offen offset:512 sc1
    s_waitcnt vmcnt(17)
    s_barrier
    s_add_u32 m0, s62, 114688
    s_add_u32 s40, s54, 202752
    buffer_load_dwordx4 v232, s[12:15], s40 offen lds
    s_add_u32 m0, s62, 122880
    s_add_u32 s40, s54, 571392
    buffer_load_dwordx4 v232, s[12:15], s40 offen lds
    s_add_u32 m0, s62, 131072
    s_add_u32 s40, s54, 866304
    buffer_load_dwordx4 v232, s[12:15], s40 offen lds
    s_add_u32 m0, s62, 139264
    s_add_u32 s40, s54, 1234944
    buffer_load_dwordx4 v232, s[12:15], s40 offen lds
    v_xor_b32 v176, 0, v160
    v_add_u32 v184, 73728, v176
    v_xor_b32 v177, 32, v160
    v_add_u32 v185, 73728, v177
    v_xor_b32 v178, 64, v160
    v_add_u32 v186, 73728, v178
    v_xor_b32 v179, 96, v160
    v_add_u32 v187, 73728, v179
    v_xor_b32 v180, 128, v160
    v_add_u32 v188, 73728, v180
    v_xor_b32 v181, 160, v160
    v_add_u32 v189, 73728, v181
    v_xor_b32 v182, 192, v160
    v_add_u32 v190, 73728, v182
    v_xor_b32 v183, 224, v160
    v_add_u32 v191, 73728, v183
    v_mov_b32 v192, v166
    v_add_u32 v193, 73728, v166
    s_add_u32 s95, s53, 18432
    ds_read_b64_tr_b16 v[72:73], v176 offset:36864
    ds_read_b64_tr_b16 v[74:75], v176 offset:38912
    ds_read_b64_tr_b16 v[76:77], v177 offset:36864
    ds_read_b64_tr_b16 v[78:79], v177 offset:38912
    ds_read_b64_tr_b16 v[80:81], v178 offset:36864
    ds_read_b64_tr_b16 v[82:83], v178 offset:38912
    ds_read_b64_tr_b16 v[84:85], v179 offset:36864
    ds_read_b64_tr_b16 v[86:87], v179 offset:38912
    s_waitcnt vmcnt(14)
    s_waitcnt lgkmcnt(6)
    v_mfma_f32_16x16x32_bf16 v[0:3], v[72:75], v[96:99], 0
    ds_read_b64_tr_b16 v[88:89], v180 offset:36864
    v_mfma_f32_16x16x32_bf16 v[4:7], v[72:75], v[100:103], 0
    ds_read_b64_tr_b16 v[90:91], v180 offset:38912
    s_waitcnt vmcnt(4)
    v_lshlrev_b32 v168, 4, v243
    v_mov_b32 v169, s35
    v_cmp_gt_u32 vcc, 3, v243
    s_add_u32 s38, s47, 96
    s_and_saveexec_b64 s[58:59], vcc
    buffer_store_dword v169, v168, s[20:23], s38 offen sc1
    s_mov_b64 exec, s[58:59]
    s_waitcnt lgkmcnt(6)
    v_mfma_f32_16x16x32_bf16 v[8:11], v[76:79], v[96:99], 0
    ds_read_b64_tr_b16 v[92:93], v181 offset:36864
    v_mfma_f32_16x16x32_bf16 v[12:15], v[76:79], v[100:103], 0
    ds_read_b64_tr_b16 v[94:95], v181 offset:38912
    s_waitcnt lgkmcnt(6)
    v_mfma_f32_16x16x32_bf16 v[16:19], v[80:83], v[96:99], 0
    ds_read_b64_tr_b16 v[72:73], v182 offset:36864
    v_mfma_f32_16x16x32_bf16 v[20:23], v[80:83], v[100:103], 0
    ds_read_b64_tr_b16 v[74:75], v182 offset:38912
    s_waitcnt lgkmcnt(6)
    v_mfma_f32_16x16x32_bf16 v[24:27], v[84:87], v[96:99], 0
    ds_read_b64_tr_b16 v[76:77], v183 offset:36864
    v_mfma_f32_16x16x32_bf16 v[28:31], v[84:87], v[100:103], 0
    ds_read_b64_tr_b16 v[78:79], v183 offset:38912
    s_waitcnt lgkmcnt(6)
    v_mfma_f32_16x16x32_bf16 v[32:35], v[88:91], v[96:99], 0
    ds_read_b64_tr_b16 v[80:81], v192 offset:36864
    v_mfma_f32_16x16x32_bf16 v[36:39], v[88:91], v[100:103], 0
    ds_read_b64_tr_b16 v[82:83], v192 offset:37120
    s_waitcnt lgkmcnt(6)
    v_mfma_f32_16x16x32_bf16 v[40:43], v[92:95], v[96:99], 0
    ds_read_b64_tr_b16 v[84:85], v176 offset:45056
    v_mfma_f32_16x16x32_bf16 v[44:47], v[92:95], v[100:103], 0
    ds_read_b64_tr_b16 v[86:87], v176 offset:47104
    s_waitcnt lgkmcnt(6)
    v_mfma_f32_16x16x32_bf16 v[48:51], v[72:75], v[96:99], 0
    ds_read_b64_tr_b16 v[88:89], v177 offset:45056
    v_mfma_f32_16x16x32_bf16 v[52:55], v[72:75], v[100:103], 0
    ds_read_b64_tr_b16 v[90:91], v177 offset:47104
    s_waitcnt lgkmcnt(6)
    v_mfma_f32_16x16x32_bf16 v[56:59], v[76:79], v[96:99], 0
    ds_read_b64_tr_b16 v[92:93], v178 offset:45056
    v_mfma_f32_16x16x32_bf16 v[60:63], v[76:79], v[100:103], 0
    ds_read_b64_tr_b16 v[94:95], v178 offset:47104
    s_waitcnt lgkmcnt(6)
    v_mfma_f32_16x16x32_bf16 v[64:67], v[80:83], v[96:99], 0
    ds_read_b64_tr_b16 v[72:73], v179 offset:45056
    v_mfma_f32_16x16x32_bf16 v[68:71], v[80:83], v[100:103], 0
    ds_read_b64_tr_b16 v[74:75], v179 offset:47104
    s_waitcnt lgkmcnt(6)
    v_mfma_f32_16x16x32_bf16 v[0:3], v[84:87], v[104:107], v[0:3]
    ds_read_b64_tr_b16 v[76:77], v180 offset:45056
    v_mfma_f32_16x16x32_bf16 v[4:7], v[84:87], v[108:111], v[4:7]
    ds_read_b64_tr_b16 v[78:79], v180 offset:47104
    s_waitcnt lgkmcnt(6)
    v_mfma_f32_16x16x32_bf16 v[8:11], v[88:91], v[104:107], v[8:11]
    ds_read_b64_tr_b16 v[80:81], v181 offset:45056
    v_mfma_f32_16x16x32_bf16 v[12:15], v[88:91], v[108:111], v[12:15]
    ds_read_b64_tr_b16 v[82:83], v181 offset:47104
    s_add_u32 s39, s53, 10240
    buffer_load_dwordx4 v[128:131], v165, s[20:23], s39 offen offset:0 sc1
    s_waitcnt lgkmcnt(6)
    v_mfma_f32_16x16x32_bf16 v[16:19], v[92:95], v[104:107], v[16:19]
    ds_read_b64_tr_b16 v[84:85], v182 offset:45056
    v_mfma_f32_16x16x32_bf16 v[20:23], v[92:95], v[108:111], v[20:23]
    ds_read_b64_tr_b16 v[86:87], v182 offset:47104
    buffer_load_dwordx4 v[132:135], v165, s[20:23], s39 offen offset:1024 sc1
    s_waitcnt lgkmcnt(6)
    v_mfma_f32_16x16x32_bf16 v[24:27], v[72:75], v[104:107], v[24:27]
    ds_read_b64_tr_b16 v[88:89], v183 offset:45056
    v_mfma_f32_16x16x32_bf16 v[28:31], v[72:75], v[108:111], v[28:31]
    ds_read_b64_tr_b16 v[90:91], v183 offset:47104
    s_add_u32 s39, s95, 10240
    buffer_load_dwordx4 v[136:139], v165, s[20:23], s39 offen offset:0 sc1
    s_waitcnt lgkmcnt(6)
    v_mfma_f32_16x16x32_bf16 v[32:35], v[76:79], v[104:107], v[32:35]
    ds_read_b64_tr_b16 v[92:93], v192 offset:37888
    v_mfma_f32_16x16x32_bf16 v[36:39], v[76:79], v[108:111], v[36:39]
    ds_read_b64_tr_b16 v[94:95], v192 offset:38144
    buffer_load_dwordx4 v[140:143], v165, s[20:23], s39 offen offset:1024 sc1
    s_barrier
    s_waitcnt lgkmcnt(6)
    v_mfma_f32_16x16x32_bf16 v[40:43], v[80:83], v[104:107], v[40:43]
    ds_read_b64_tr_b16 v[72:73], v184 offset:0
    v_mfma_f32_16x16x32_bf16 v[44:47], v[80:83], v[108:111], v[44:47]
    ds_read_b64_tr_b16 v[74:75], v184 offset:2048
    s_add_u32 m0, s62, 4096
    s_add_u32 s40, s54, 239616
    buffer_load_dwordx4 v232, s[12:15], s40 offen lds
    s_waitcnt lgkmcnt(6)
    v_mfma_f32_16x16x32_bf16 v[48:51], v[84:87], v[104:107], v[48:51]
    ds_read_b64_tr_b16 v[76:77], v185 offset:0
    v_mfma_f32_16x16x32_bf16 v[52:55], v[84:87], v[108:111], v[52:55]
    ds_read_b64_tr_b16 v[78:79], v185 offset:2048
    s_add_u32 m0, s62, 12288
    s_add_u32 s40, s54, 608256
    buffer_load_dwordx4 v232, s[12:15], s40 offen lds
    s_waitcnt lgkmcnt(6)
    v_mfma_f32_16x16x32_bf16 v[56:59], v[88:91], v[104:107], v[56:59]
    ds_read_b64_tr_b16 v[80:81], v186 offset:0
    v_mfma_f32_16x16x32_bf16 v[60:63], v[88:91], v[108:111], v[60:63]
    ds_read_b64_tr_b16 v[82:83], v186 offset:2048
    s_add_u32 m0, s62, 20480
    s_add_u32 s40, s54, 903168
    buffer_load_dwordx4 v232, s[12:15], s40 offen lds
    s_waitcnt lgkmcnt(6)
    v_mfma_f32_16x16x32_bf16 v[64:67], v[92:95], v[104:107], v[64:67]
    ds_read_b64_tr_b16 v[84:85], v187 offset:0
    v_mfma_f32_16x16x32_bf16 v[68:71], v[92:95], v[108:111], v[68:71]
    ds_read_b64_tr_b16 v[86:87], v187 offset:2048
    s_add_u32 m0, s62, 28672
    s_add_u32 s40, s54, 1271808
    buffer_load_dwordx4 v232, s[12:15], s40 offen lds
    s_waitcnt lgkmcnt(6)
    v_mfma_f32_16x16x32_bf16 v[0:3], v[72:75], v[112:115], v[0:3]
    ds_read_b64_tr_b16 v[88:89], v188 offset:0
    v_mfma_f32_16x16x32_bf16 v[4:7], v[72:75], v[116:119], v[4:7]
    ds_read_b64_tr_b16 v[90:91], v188 offset:2048
    s_waitcnt lgkmcnt(6)
    v_mfma_f32_16x16x32_bf16 v[8:11], v[76:79], v[112:115], v[8:11]
    ds_read_b64_tr_b16 v[92:93], v189 offset:0
    v_mfma_f32_16x16x32_bf16 v[12:15], v[76:79], v[116:119], v[12:15]
    ds_read_b64_tr_b16 v[94:95], v189 offset:2048
    s_waitcnt lgkmcnt(6)
    v_mfma_f32_16x16x32_bf16 v[16:19], v[80:83], v[112:115], v[16:19]
    ds_read_b64_tr_b16 v[72:73], v190 offset:0
    v_mfma_f32_16x16x32_bf16 v[20:23], v[80:83], v[116:119], v[20:23]
    ds_read_b64_tr_b16 v[74:75], v190 offset:2048
    s_waitcnt lgkmcnt(6)
    v_mfma_f32_16x16x32_bf16 v[24:27], v[84:87], v[112:115], v[24:27]
    ds_read_b64_tr_b16 v[76:77], v191 offset:0
    v_mfma_f32_16x16x32_bf16 v[28:31], v[84:87], v[116:119], v[28:31]
    ds_read_b64_tr_b16 v[78:79], v191 offset:2048
    s_waitcnt lgkmcnt(6)
    v_mfma_f32_16x16x32_bf16 v[32:35], v[88:91], v[112:115], v[32:35]
    ds_read_b64_tr_b16 v[80:81], v193 offset:0
    v_mfma_f32_16x16x32_bf16 v[36:39], v[88:91], v[116:119], v[36:39]
    ds_read_b64_tr_b16 v[82:83], v193 offset:256
    s_waitcnt lgkmcnt(6)
    v_mfma_f32_16x16x32_bf16 v[40:43], v[92:95], v[112:115], v[40:43]
    ds_read_b64_tr_b16 v[84:85], v184 offset:8192
    v_mfma_f32_16x16x32_bf16 v[44:47], v[92:95], v[116:119], v[44:47]
    ds_read_b64_tr_b16 v[86:87], v184 offset:10240
    s_waitcnt lgkmcnt(6)
    v_mfma_f32_16x16x32_bf16 v[48:51], v[72:75], v[112:115], v[48:51]
    ds_read_b64_tr_b16 v[88:89], v185 offset:8192
    v_mfma_f32_16x16x32_bf16 v[52:55], v[72:75], v[116:119], v[52:55]
    ds_read_b64_tr_b16 v[90:91], v185 offset:10240
    s_waitcnt lgkmcnt(6)
    v_mfma_f32_16x16x32_bf16 v[56:59], v[76:79], v[112:115], v[56:59]
    ds_read_b64_tr_b16 v[92:93], v186 offset:8192
    v_mfma_f32_16x16x32_bf16 v[60:63], v[76:79], v[116:119], v[60:63]
    ds_read_b64_tr_b16 v[94:95], v186 offset:10240
    s_waitcnt lgkmcnt(6)
    v_mfma_f32_16x16x32_bf16 v[64:67], v[80:83], v[112:115], v[64:67]
    ds_read_b64_tr_b16 v[72:73], v187 offset:8192
    v_mfma_f32_16x16x32_bf16 v[68:71], v[80:83], v[116:119], v[68:71]
    ds_read_b64_tr_b16 v[74:75], v187 offset:10240
    s_waitcnt lgkmcnt(6)
    v_mfma_f32_16x16x32_bf16 v[0:3], v[84:87], v[120:123], v[0:3]
    ds_read_b64_tr_b16 v[76:77], v188 offset:8192
    v_mfma_f32_16x16x32_bf16 v[4:7], v[84:87], v[124:127], v[4:7]
    ds_read_b64_tr_b16 v[78:79], v188 offset:10240
    s_waitcnt lgkmcnt(6)
    v_mfma_f32_16x16x32_bf16 v[8:11], v[88:91], v[120:123], v[8:11]
    ds_read_b64_tr_b16 v[80:81], v189 offset:8192
    v_mfma_f32_16x16x32_bf16 v[12:15], v[88:91], v[124:127], v[12:15]
    ds_read_b64_tr_b16 v[82:83], v189 offset:10240
    buffer_load_dword v163, v164, s[20:23], s60 offen sc1
    s_waitcnt lgkmcnt(6)
    v_mfma_f32_16x16x32_bf16 v[16:19], v[92:95], v[120:123], v[16:19]
    ds_read_b64_tr_b16 v[84:85], v190 offset:8192
    v_mfma_f32_16x16x32_bf16 v[20:23], v[92:95], v[124:127], v[20:23]
    ds_read_b64_tr_b16 v[86:87], v190 offset:10240
    s_waitcnt lgkmcnt(6)
    v_mfma_f32_16x16x32_bf16 v[24:27], v[72:75], v[120:123], v[24:27]
    ds_read_b64_tr_b16 v[88:89], v191 offset:8192
    v_mfma_f32_16x16x32_bf16 v[28:31], v[72:75], v[124:127], v[28:31]
    ds_read_b64_tr_b16 v[90:91], v191 offset:10240
    s_waitcnt lgkmcnt(6)
    v_mfma_f32_16x16x32_bf16 v[32:35], v[76:79], v[120:123], v[32:35]
    ds_read_b64_tr_b16 v[92:93], v193 offset:1024
    v_mfma_f32_16x16x32_bf16 v[36:39], v[76:79], v[124:127], v[36:39]
    ds_read_b64_tr_b16 v[94:95], v193 offset:1280
    s_waitcnt vmcnt(10)
    s_barrier
    s_waitcnt lgkmcnt(6)
    v_mfma_f32_16x16x32_bf16 v[40:43], v[80:83], v[120:123], v[40:43]
    ds_read_b64_tr_b16 v[72:73], v184 offset:36864
    v_mfma_f32_16x16x32_bf16 v[44:47], v[80:83], v[124:127], v[44:47]
    ds_read_b64_tr_b16 v[74:75], v184 offset:38912
    s_add_u32 m0, s62, 40960
    s_add_u32 s40, s54, 276480
    buffer_load_dwordx4 v232, s[12:15], s40 offen lds
    s_waitcnt lgkmcnt(6)
    v_mfma_f32_16x16x32_bf16 v[48:51], v[84:87], v[120:123], v[48:51]
    ds_read_b64_tr_b16 v[76:77], v185 offset:36864
    v_mfma_f32_16x16x32_bf16 v[52:55], v[84:87], v[124:127], v[52:55]
    ds_read_b64_tr_b16 v[78:79], v185 offset:38912
    s_add_u32 m0, s62, 49152
    s_add_u32 s40, s54, 645120
    buffer_load_dwordx4 v232, s[12:15], s40 offen lds
    s_waitcnt lgkmcnt(6)
    v_mfma_f32_16x16x32_bf16 v[56:59], v[88:91], v[120:123], v[56:59]
    ds_read_b64_tr_b16 v[80:81], v186 offset:36864
    v_mfma_f32_16x16x32_bf16 v[60:63], v[88:91], v[124:127], v[60:63]
    ds_read_b64_tr_b16 v[82:83], v186 offset:38912
    s_add_u32 m0, s62, 57344
    s_add_u32 s40, s54, 940032
    buffer_load_dwordx4 v232, s[12:15], s40 offen lds
    s_waitcnt lgkmcnt(6)
    v_mfma_f32_16x16x32_bf16 v[64:67], v[92:95], v[120:123], v[64:67]
    ds_read_b64_tr_b16 v[84:85], v187 offset:36864
    v_mfma_f32_16x16x32_bf16 v[68:71], v[92:95], v[124:127], v[68:71]
    ds_read_b64_tr_b16 v[86:87], v187 offset:38912
    s_add_u32 m0, s62, 65536
    s_add_u32 s40, s54, 1308672
    buffer_load_dwordx4 v232, s[12:15], s40 offen lds
    s_waitcnt vmcnt(9)
    s_waitcnt lgkmcnt(6)
    v_mfma_f32_16x16x32_bf16 v[0:3], v[72:75], v[128:131], v[0:3]
    ds_read_b64_tr_b16 v[88:89], v188 offset:36864
    v_mfma_f32_16x16x32_bf16 v[4:7], v[72:75], v[132:135], v[4:7]
    ds_read_b64_tr_b16 v[90:91], v188 offset:38912
    s_waitcnt vmcnt(4)
    v_cmp_ne_u32 vcc, s35, v163
    s_and_b32 s38, vcc_lo, 0xff000000
    s_and_b32 s39, vcc_hi, 0xf
    s_or_b32 s38, s38, s39
    s_cbranch_scc0 L_ok_3
    s_mov_b32 s61, 0
L_spin_3:
    buffer_load_dword v163, v164, s[20:23], s60 offen sc1
    s_add_u32 s61, s61, 1
    s_cmp_gt_u32 s61, 200000
    s_cbranch_scc1 L_ok_3
    s_waitcnt vmcnt(0)
    v_cmp_ne_u32 vcc, s35, v163
    s_and_b32 s38, vcc_lo, 0xff000000
    s_and_b32 s39, vcc_hi, 0xf
    s_or_b32 s38, s38, s39
    s_cbranch_scc1 L_spin_3
L_ok_3:
    s_waitcnt lgkmcnt(6)
    v_mfma_f32_16x16x32_bf16 v[8:11], v[76:79], v[128:131], v[8:11]
    ds_read_b64_tr_b16 v[92:93], v189 offset:36864
    v_mfma_f32_16x16x32_bf16 v[12:15], v[76:79], v[132:135], v[12:15]
    ds_read_b64_tr_b16 v[94:95], v189 offset:38912
    s_add_u32 s39, s53, 12288
    buffer_load_dwordx4 v[96:99], v165, s[20:23], s39 offen offset:0 sc1
    s_waitcnt lgkmcnt(6)
    v_mfma_f32_16x16x32_bf16 v[16:19], v[80:83], v[128:131], v[16:19]
    ds_read_b64_tr_b16 v[72:73], v190 offset:36864
    v_mfma_f32_16x16x32_bf16 v[20:23], v[80:83], v[132:135], v[20:23]
    ds_read_b64_tr_b16 v[74:75], v190 offset:38912
    buffer_load_dwordx4 v[100:103], v165, s[20:23], s39 offen offset:1024 sc1
    s_waitcnt lgkmcnt(6)
    v_mfma_f32_16x16x32_bf16 v[24:27], v[84:87], v[128:131], v[24:27]
    ds_read_b64_tr_b16 v[76:77], v191 offset:36864
    v_mfma_f32_16x16x32_bf16 v[28:31], v[84:87], v[132:135], v[28:31]
    ds_read_b64_tr_b16 v[78:79], v191 offset:38912
    s_add_u32 s39, s95, 12288
    buffer_load_dwordx4 v[104:107], v165, s[20:23], s39 offen offset:0 sc1
    s_waitcnt lgkmcnt(6)
    v_mfma_f32_16x16x32_bf16 v[32:35], v[88:91], v[128:131], v[32:35]
    ds_read_b64_tr_b16 v[80:81], v193 offset:36864
    v_mfma_f32_16x16x32_bf16 v[36:39], v[88:91], v[132:135], v[36:39]
    ds_read_b64_tr_b16 v[82:83], v193 offset:37120
    buffer_load_dwordx4 v[108:111], v165, s[20:23], s39 offen offset:1024 sc1
    s_waitcnt lgkmcnt(6)
    v_mfma_f32_16x16x32_bf16 v[40:43], v[92:95], v[128:131], v[40:43]
    ds_read_b64_tr_b16 v[84:85], v184 offset:45056
    v_mfma_f32_16x16x32_bf16 v[44:47], v[92:95], v[132:135], v[44:47]
    ds_read_b64_tr_b16 v[86:87], v184 offset:47104
    s_waitcnt lgkmcnt(6)
    v_mfma_f32_16x16x32_bf16 v[48:51], v[72:75], v[128:131], v[48:51]
    ds_read_b64_tr_b16 v[88:89], v185 offset:45056
    v_mfma_f32_16x16x32_bf16 v[52:55], v[72:75], v[132:135], v[52:55]
    ds_read_b64_tr_b16 v[90:91], v185 offset:47104
    s_waitcnt lgkmcnt(6)
    v_mfma_f32_16x16x32_bf16 v[56:59], v[76:79], v[128:131], v[56:59]
    ds_read_b64_tr_b16 v[92:93], v186 offset:45056
    v_mfma_f32_16x16x32_bf16 v[60:63], v[76:79], v[132:135], v[60:63]
    ds_read_b64_tr_b16 v[94:95], v186 offset:47104
    s_waitcnt lgkmcnt(6)
    v_mfma_f32_16x16x32_bf16 v[64:67], v[80:83], v[128:131], v[64:67]
    ds_read_b64_tr_b16 v[72:73], v187 offset:45056
    v_mfma_f32_16x16x32_bf16 v[68:71], v[80:83], v[132:135], v[68:71]
    ds_read_b64_tr_b16 v[74:75], v187 offset:47104
    s_waitcnt lgkmcnt(6)
    v_mfma_f32_16x16x32_bf16 v[0:3], v[84:87], v[136:139], v[0:3]
    ds_read_b64_tr_b16 v[76:77], v188 offset:45056
    v_mfma_f32_16x16x32_bf16 v[4:7], v[84:87], v[140:143], v[4:7]
    ds_read_b64_tr_b16 v[78:79], v188 offset:47104
    s_waitcnt lgkmcnt(6)
    v_mfma_f32_16x16x32_bf16 v[8:11], v[88:91], v[136:139], v[8:11]
    ds_read_b64_tr_b16 v[80:81], v189 offset:45056
    v_mfma_f32_16x16x32_bf16 v[12:15], v[88:91], v[140:143], v[12:15]
    ds_read_b64_tr_b16 v[82:83], v189 offset:47104
    s_add_u32 s39, s53, 14336
    buffer_load_dwordx4 v[112:115], v165, s[20:23], s39 offen offset:0 sc1
    s_waitcnt lgkmcnt(6)
    v_mfma_f32_16x16x32_bf16 v[16:19], v[92:95], v[136:139], v[16:19]
    ds_read_b64_tr_b16 v[84:85], v190 offset:45056
    v_mfma_f32_16x16x32_bf16 v[20:23], v[92:95], v[140:143], v[20:23]
    ds_read_b64_tr_b16 v[86:87], v190 offset:47104
    buffer_load_dwordx4 v[116:119], v165, s[20:23], s39 offen offset:1024 sc1
    s_waitcnt lgkmcnt(6)
    v_mfma_f32_16x16x32_bf16 v[24:27], v[72:75], v[136:139], v[24:27]
    ds_read_b64_tr_b16 v[88:89], v191 offset:45056
    v_mfma_f32_16x16x32_bf16 v[28:31], v[72:75], v[140:143], v[28:31]
    ds_read_b64_tr_b16 v[90:91], v191 offset:47104
    s_add_u32 s39, s95, 14336
    buffer_load_dwordx4 v[120:123], v165, s[20:23], s39 offen offset:0 sc1
    s_waitcnt lgkmcnt(6)
    v_mfma_f32_16x16x32_bf16 v[32:35], v[76:79], v[136:139], v[32:35]
    ds_read_b64_tr_b16 v[92:93], v193 offset:37888
    v_mfma_f32_16x16x32_bf16 v[36:39], v[76:79], v[140:143], v[36:39]
    ds_read_b64_tr_b16 v[94:95], v193 offset:38144
    buffer_load_dwordx4 v[124:127], v165, s[20:23], s39 offen offset:1024 sc1
    s_barrier
    s_waitcnt lgkmcnt(6)
    v_mfma_f32_16x16x32_bf16 v[40:43], v[80:83], v[136:139], v[40:43]
    ds_read_b64_tr_b16 v[72:73], v176 offset:0
    v_mfma_f32_16x16x32_bf16 v[44:47], v[80:83], v[140:143], v[44:47]
    ds_read_b64_tr_b16 v[74:75], v176 offset:2048
    s_add_u32 m0, s62, 77824
    s_add_u32 s40, s54, 313344
    buffer_load_dwordx4 v232, s[12:15], s40 offen lds
    s_waitcnt lgkmcnt(6)
    v_mfma_f32_16x16x32_bf16 v[48:51], v[84:87], v[136:139], v[48:51]
    ds_read_b64_tr_b16 v[76:77], v177 offset:0
    v_mfma_f32_16x16x32_bf16 v[52:55], v[84:87], v[140:143], v[52:55]
    ds_read_b64_tr_b16 v[78:79], v177 offset:2048
    s_add_u32 m0, s62, 86016
    s_add_u32 s40, s54, 350208
    buffer_load_dwordx4 v232, s[12:15], s40 offen lds
    s_waitcnt lgkmcnt(6)
    v_mfma_f32_16x16x32_bf16 v[56:59], v[88:91], v[136:139], v[56:59]
    ds_read_b64_tr_b16 v[80:81], v178 offset:0
    v_mfma_f32_16x16x32_bf16 v[60:63], v[88:91], v[140:143], v[60:63]
    ds_read_b64_tr_b16 v[82:83], v178 offset:2048
    s_add_u32 m0, s62, 94208
    s_add_u32 s40, s54, 976896
    buffer_load_dwordx4 v232, s[12:15], s40 offen lds
    s_waitcnt lgkmcnt(6)
    v_mfma_f32_16x16x32_bf16 v[64:67], v[92:95], v[136:139], v[64:67]
    ds_read_b64_tr_b16 v[84:85], v179 offset:0
    v_mfma_f32_16x16x32_bf16 v[68:71], v[92:95], v[140:143], v[68:71]
    ds_read_b64_tr_b16 v[86:87], v179 offset:2048
    s_add_u32 m0, s62, 102400
    s_add_u32 s40, s54, 1013760
    buffer_load_dwordx4 v232, s[12:15], s40 offen lds
    s_waitcnt vmcnt(8)
    s_waitcnt lgkmcnt(6)
    v_mfma_f32_16x16x32_bf16 v[0:3], v[72:75], v[96:99], v[0:3]
    ds_read_b64_tr_b16 v[88:89], v180 offset:0
    v_mfma_f32_16x16x32_bf16 v[4:7], v[72:75], v[100:103], v[4:7]
    ds_read_b64_tr_b16 v[90:91], v180 offset:2048
    s_waitcnt lgkmcnt(6)
    v_mfma_f32_16x16x32_bf16 v[8:11], v[76:79], v[96:99], v[8:11]
    ds_read_b64_tr_b16 v[92:93], v181 offset:0
    v_mfma_f32_16x16x32_bf16 v[12:15], v[76:79], v[100:103], v[12:15]
    ds_read_b64_tr_b16 v[94:95], v181 offset:2048
    s_waitcnt lgkmcnt(6)
    v_mfma_f32_16x16x32_bf16 v[16:19], v[80:83], v[96:99], v[16:19]
    ds_read_b64_tr_b16 v[72:73], v182 offset:0
    v_mfma_f32_16x16x32_bf16 v[20:23], v[80:83], v[100:103], v[20:23]
    ds_read_b64_tr_b16 v[74:75], v182 offset:2048
    s_waitcnt lgkmcnt(6)
    v_mfma_f32_16x16x32_bf16 v[24:27], v[84:87], v[96:99], v[24:27]
    ds_read_b64_tr_b16 v[76:77], v183 offset:0
    v_mfma_f32_16x16x32_bf16 v[28:31], v[84:87], v[100:103], v[28:31]
    ds_read_b64_tr_b16 v[78:79], v183 offset:2048
    s_waitcnt lgkmcnt(6)
    v_mfma_f32_16x16x32_bf16 v[32:35], v[88:91], v[96:99], v[32:35]
    ds_read_b64_tr_b16 v[80:81], v192 offset:0
    v_mfma_f32_16x16x32_bf16 v[36:39], v[88:91], v[100:103], v[36:39]
    ds_read_b64_tr_b16 v[82:83], v192 offset:256
    s_waitcnt lgkmcnt(6)
    v_mfma_f32_16x16x32_bf16 v[40:43], v[92:95], v[96:99], v[40:43]
    ds_read_b64_tr_b16 v[84:85], v176 offset:8192
    v_mfma_f32_16x16x32_bf16 v[44:47], v[92:95], v[100:103], v[44:47]
    ds_read_b64_tr_b16 v[86:87], v176 offset:10240
    s_waitcnt lgkmcnt(6)
    v_mfma_f32_16x16x32_bf16 v[48:51], v[72:75], v[96:99], v[48:51]
    ds_read_b64_tr_b16 v[88:89], v177 offset:8192
    v_mfma_f32_16x16x32_bf16 v[52:55], v[72:75], v[100:103], v[52:55]
    ds_read_b64_tr_b16 v[90:91], v177 offset:10240
    s_waitcnt lgkmcnt(6)
    v_mfma_f32_16x16x32_bf16 v[56:59], v[76:79], v[96:99], v[56:59]
    ds_read_b64_tr_b16 v[92:93], v178 offset:8192
    v_mfma_f32_16x16x32_bf16 v[60:63], v[76:79], v[100:103], v[60:63]
    ds_read_b64_tr_b16 v[94:95], v178 offset:10240
    s_waitcnt lgkmcnt(6)
    v_mfma_f32_16x16x32_bf16 v[64:67], v[80:83], v[96:99], v[64:67]
    ds_read_b64_tr_b16 v[72:73], v179 offset:8192
    v_mfma_f32_16x16x32_bf16 v[68:71], v[80:83], v[100:103], v[68:71]
    ds_read_b64_tr_b16 v[74:75], v179 offset:10240
    s_waitcnt lgkmcnt(6)
    v_mfma_f32_16x16x32_bf16 v[0:3], v[84:87], v[104:107], v[0:3]
    ds_read_b64_tr_b16 v[76:77], v180 offset:8192
    v_mfma_f32_16x16x32_bf16 v[4:7], v[84:87], v[108:111], v[4:7]
    ds_read_b64_tr_b16 v[78:79], v180 offset:10240
    s_waitcnt lgkmcnt(6)
    v_mfma_f32_16x16x32_bf16 v[8:11], v[88:91], v[104:107], v[8:11]
    ds_read_b64_tr_b16 v[80:81], v181 offset:8192
    v_mfma_f32_16x16x32_bf16 v[12:15], v[88:91], v[108:111], v[12:15]
    ds_read_b64_tr_b16 v[82:83], v181 offset:10240
    s_add_u32 s39, s53, 16384
    buffer_load_dwordx4 v[128:131], v165, s[20:23], s39 offen offset:0 sc1
    s_waitcnt lgkmcnt(6)
    v_mfma_f32_16x16x32_bf16 v[16:19], v[92:95], v[104:107], v[16:19]
    ds_read_b64_tr_b16 v[84:85], v182 offset:8192
    v_mfma_f32_16x16x32_bf16 v[20:23], v[92:95], v[108:111], v[20:23]
    ds_read_b64_tr_b16 v[86:87], v182 offset:10240
    buffer_load_dwordx4 v[132:135], v165, s[20:23], s39 offen offset:1024 sc1
    s_waitcnt lgkmcnt(6)
    v_mfma_f32_16x16x32_bf16 v[24:27], v[72:75], v[104:107], v[24:27]
    ds_read_b64_tr_b16 v[88:89], v183 offset:8192
    v_mfma_f32_16x16x32_bf16 v[28:31], v[72:75], v[108:111], v[28:31]
    ds_read_b64_tr_b16 v[90:91], v183 offset:10240
    s_add_u32 s39, s95, 16384
    buffer_load_dwordx4 v[136:139], v165, s[20:23], s39 offen offset:0 sc1
    s_waitcnt lgkmcnt(6)
    v_mfma_f32_16x16x32_bf16 v[32:35], v[76:79], v[104:107], v[32:35]
    ds_read_b64_tr_b16 v[92:93], v192 offset:1024
    v_mfma_f32_16x16x32_bf16 v[36:39], v[76:79], v[108:111], v[36:39]
    ds_read_b64_tr_b16 v[94:95], v192 offset:1280
    buffer_load_dwordx4 v[140:143], v165, s[20:23], s39 offen offset:1024 sc1
    s_barrier
    s_waitcnt lgkmcnt(6)
    v_mfma_f32_16x16x32_bf16 v[40:43], v[80:83], v[104:107], v[40:43]
    ds_read_b64_tr_b16 v[72:73], v176 offset:36864
    v_mfma_f32_16x16x32_bf16 v[44:47], v[80:83], v[108:111], v[44:47]
    ds_read_b64_tr_b16 v[74:75], v176 offset:38912
    s_waitcnt lgkmcnt(6)
    v_mfma_f32_16x16x32_bf16 v[48:51], v[84:87], v[104:107], v[48:51]
    ds_read_b64_tr_b16 v[76:77], v177 offset:36864
    v_mfma_f32_16x16x32_bf16 v[52:55], v[84:87], v[108:111], v[52:55]
    ds_read_b64_tr_b16 v[78:79], v177 offset:38912
    s_waitcnt lgkmcnt(6)
    v_mfma_f32_16x16x32_bf16 v[56:59], v[88:91], v[104:107], v[56:59]
    ds_read_b64_tr_b16 v[80:81], v178 offset:36864
    v_mfma_f32_16x16x32_bf16 v[60:63], v[88:91], v[108:111], v[60:63]
    ds_read_b64_tr_b16 v[82:83], v178 offset:38912
    s_waitcnt lgkmcnt(6)
    v_mfma_f32_16x16x32_bf16 v[64:67], v[92:95], v[104:107], v[64:67]
    ds_read_b64_tr_b16 v[84:85], v179 offset:36864
    v_mfma_f32_16x16x32_bf16 v[68:71], v[92:95], v[108:111], v[68:71]
    ds_read_b64_tr_b16 v[86:87], v179 offset:38912
    s_waitcnt vmcnt(8)
    s_waitcnt lgkmcnt(6)
    v_mfma_f32_16x16x32_bf16 v[0:3], v[72:75], v[112:115], v[0:3]
    ds_read_b64_tr_b16 v[88:89], v180 offset:36864
    v_mfma_f32_16x16x32_bf16 v[4:7], v[72:75], v[116:119], v[4:7]
    ds_read_b64_tr_b16 v[90:91], v180 offset:38912
    s_waitcnt lgkmcnt(6)
    v_mfma_f32_16x16x32_bf16 v[8:11], v[76:79], v[112:115], v[8:11]
    ds_read_b64_tr_b16 v[92:93], v181 offset:36864
    v_mfma_f32_16x16x32_bf16 v[12:15], v[76:79], v[116:119], v[12:15]
    ds_read_b64_tr_b16 v[94:95], v181 offset:38912
    s_waitcnt lgkmcnt(6)
    v_mfma_f32_16x16x32_bf16 v[16:19], v[80:83], v[112:115], v[16:19]
    ds_read_b64_tr_b16 v[72:73], v182 offset:36864
    v_mfma_f32_16x16x32_bf16 v[20:23], v[80:83], v[116:119], v[20:23]
    ds_read_b64_tr_b16 v[74:75], v182 offset:38912
    s_waitcnt lgkmcnt(6)
    v_mfma_f32_16x16x32_bf16 v[24:27], v[84:87], v[112:115], v[24:27]
    ds_read_b64_tr_b16 v[76:77], v183 offset:36864
    v_mfma_f32_16x16x32_bf16 v[28:31], v[84:87], v[116:119], v[28:31]
    ds_read_b64_tr_b16 v[78:79], v183 offset:38912
    s_waitcnt lgkmcnt(6)
    v_mfma_f32_16x16x32_bf16 v[32:35], v[88:91], v[112:115], v[32:35]
    ds_read_b64_tr_b16 v[80:81], v192 offset:36864
    v_mfma_f32_16x16x32_bf16 v[36:39], v[88:91], v[116:119], v[36:39]
    ds_read_b64_tr_b16 v[82:83], v192 offset:37120
    s_waitcnt lgkmcnt(6)
    v_mfma_f32_16x16x32_bf16 v[40:43], v[92:95], v[112:115], v[40:43]
    ds_read_b64_tr_b16 v[84:85], v176 offset:45056
    v_mfma_f32_16x16x32_bf16 v[44:47], v[92:95], v[116:119], v[44:47]
    ds_read_b64_tr_b16 v[86:87], v176 offset:47104
    s_waitcnt lgkmcnt(6)
    v_mfma_f32_16x16x32_bf16 v[48:51], v[72:75], v[112:115], v[48:51]
    ds_read_b64_tr_b16 v[88:89], v177 offset:45056
    v_mfma_f32_16x16x32_bf16 v[52:55], v[72:75], v[116:119], v[52:55]
    ds_read_b64_tr_b16 v[90:91], v177 offset:47104
    s_waitcnt lgkmcnt(6)
    v_mfma_f32_16x16x32_bf16 v[56:59], v[76:79], v[112:115], v[56:59]
    ds_read_b64_tr_b16 v[92:93], v178 offset:45056
    v_mfma_f32_16x16x32_bf16 v[60:63], v[76:79], v[116:119], v[60:63]
    ds_read_b64_tr_b16 v[94:95], v178 offset:47104
    s_waitcnt lgkmcnt(6)
    v_mfma_f32_16x16x32_bf16 v[64:67], v[80:83], v[112:115], v[64:67]
    ds_read_b64_tr_b16 v[72:73], v179 offset:45056
    v_mfma_f32_16x16x32_bf16 v[68:71], v[80:83], v[116:119], v[68:71]
    ds_read_b64_tr_b16 v[74:75], v179 offset:47104
    s_waitcnt lgkmcnt(6)
    v_mfma_f32_16x16x32_bf16 v[0:3], v[84:87], v[120:123], v[0:3]
    ds_read_b64_tr_b16 v[76:77], v180 offset:45056
    v_mfma_f32_16x16x32_bf16 v[4:7], v[84:87], v[124:127], v[4:7]
    ds_read_b64_tr_b16 v[78:79], v180 offset:47104
    s_waitcnt lgkmcnt(6)
    v_mfma_f32_16x16x32_bf16 v[8:11], v[88:91], v[120:123], v[8:11]
    ds_read_b64_tr_b16 v[80:81], v181 offset:45056
    v_mfma_f32_16x16x32_bf16 v[12:15], v[88:91], v[124:127], v[12:15]
    ds_read_b64_tr_b16 v[82:83], v181 offset:47104
    s_waitcnt lgkmcnt(6)
    v_mfma_f32_16x16x32_bf16 v[16:19], v[92:95], v[120:123], v[16:19]
    ds_read_b64_tr_b16 v[84:85], v182 offset:45056
    v_mfma_f32_16x16x32_bf16 v[20:23], v[92:95], v[124:127], v[20:23]
    ds_read_b64_tr_b16 v[86:87], v182 offset:47104
    s_waitcnt lgkmcnt(6)
    v_mfma_f32_16x16x32_bf16 v[24:27], v[72:75], v[120:123], v[24:27]
    ds_read_b64_tr_b16 v[88:89], v183 offset:45056
    v_mfma_f32_16x16x32_bf16 v[28:31], v[72:75], v[124:127], v[28:31]
    ds_read_b64_tr_b16 v[90:91], v183 offset:47104
    s_waitcnt lgkmcnt(6)
    v_mfma_f32_16x16x32_bf16 v[32:35], v[76:79], v[120:123], v[32:35]
    ds_read_b64_tr_b16 v[92:93], v192 offset:37888
    v_mfma_f32_16x16x32_bf16 v[36:39], v[76:79], v[124:127], v[36:39]
    ds_read_b64_tr_b16 v[94:95], v192 offset:38144
    s_waitcnt vmcnt(4)
    s_barrier
    s_waitcnt lgkmcnt(6)
    v_mfma_f32_16x16x32_bf16 v[40:43], v[80:83], v[120:123], v[40:43]
    ds_read_b64_tr_b16 v[72:73], v184 offset:0
    v_mfma_f32_16x16x32_bf16 v[44:47], v[80:83], v[124:127], v[44:47]
    ds_read_b64_tr_b16 v[74:75], v184 offset:2048
    s_waitcnt lgkmcnt(6)
    v_mfma_f32_16x16x32_bf16 v[48:51], v[84:87], v[120:123], v[48:51]
    ds_read_b64_tr_b16 v[76:77], v185 offset:0
    v_mfma_f32_16x16x32_bf16 v[52:55], v[84:87], v[124:127], v[52:55]
    ds_read_b64_tr_b16 v[78:79], v185 offset:2048
    s_waitcnt lgkmcnt(6)
    v_mfma_f32_16x16x32_bf16 v[56:59], v[88:91], v[120:123], v[56:59]
    ds_read_b64_tr_b16 v[80:81], v186 offset:0
    v_mfma_f32_16x16x32_bf16 v[60:63], v[88:91], v[124:127], v[60:63]
    ds_read_b64_tr_b16 v[82:83], v186 offset:2048
    s_waitcnt lgkmcnt(6)
    v_mfma_f32_16x16x32_bf16 v[64:67], v[92:95], v[120:123], v[64:67]
    ds_read_b64_tr_b16 v[84:85], v187 offset:0
    v_mfma_f32_16x16x32_bf16 v[68:71], v[92:95], v[124:127], v[68:71]
    ds_read_b64_tr_b16 v[86:87], v187 offset:2048
    s_waitcnt vmcnt(0)
    s_waitcnt lgkmcnt(6)
    v_mfma_f32_16x16x32_bf16 v[0:3], v[72:75], v[128:131], v[0:3]
    ds_read_b64_tr_b16 v[88:89], v188 offset:0
    v_mfma_f32_16x16x32_bf16 v[4:7], v[72:75], v[132:135], v[4:7]
    ds_read_b64_tr_b16 v[90:91], v188 offset:2048
    s_waitcnt lgkmcnt(6)
    v_mfma_f32_16x16x32_bf16 v[8:11], v[76:79], v[128:131], v[8:11]
    ds_read_b64_tr_b16 v[92:93], v189 offset:0
    v_mfma_f32_16x16x32_bf16 v[12:15], v[76:79], v[132:135], v[12:15]
    ds_read_b64_tr_b16 v[94:95], v189 offset:2048
    s_waitcnt lgkmcnt(6)
    v_mfma_f32_16x16x32_bf16 v[16:19], v[80:83], v[128:131], v[16:19]
    ds_read_b64_tr_b16 v[72:73], v190 offset:0
    v_mfma_f32_16x16x32_bf16 v[20:23], v[80:83], v[132:135], v[20:23]
    ds_read_b64_tr_b16 v[74:75], v190 offset:2048
    s_waitcnt lgkmcnt(6)
    v_mfma_f32_16x16x32_bf16 v[24:27], v[84:87], v[128:131], v[24:27]
    ds_read_b64_tr_b16 v[76:77], v191 offset:0
    v_mfma_f32_16x16x32_bf16 v[28:31], v[84:87], v[132:135], v[28:31]
    ds_read_b64_tr_b16 v[78:79], v191 offset:2048
    s_waitcnt lgkmcnt(6)
    v_mfma_f32_16x16x32_bf16 v[32:35], v[88:91], v[128:131], v[32:35]
    ds_read_b64_tr_b16 v[80:81], v193 offset:0
    v_mfma_f32_16x16x32_bf16 v[36:39], v[88:91], v[132:135], v[36:39]
    ds_read_b64_tr_b16 v[82:83], v193 offset:256
    s_waitcnt lgkmcnt(6)
    v_mfma_f32_16x16x32_bf16 v[40:43], v[92:95], v[128:131], v[40:43]
    ds_read_b64_tr_b16 v[84:85], v184 offset:8192
    v_mfma_f32_16x16x32_bf16 v[44:47], v[92:95], v[132:135], v[44:47]
    ds_read_b64_tr_b16 v[86:87], v184 offset:10240
    s_waitcnt lgkmcnt(6)
    v_mfma_f32_16x16x32_bf16 v[48:51], v[72:75], v[128:131], v[48:51]
    ds_read_b64_tr_b16 v[88:89], v185 offset:8192
    v_mfma_f32_16x16x32_bf16 v[52:55], v[72:75], v[132:135], v[52:55]
    ds_read_b64_tr_b16 v[90:91], v185 offset:10240
    s_waitcnt lgkmcnt(6)
    v_mfma_f32_16x16x32_bf16 v[56:59], v[76:79], v[128:131], v[56:59]
    ds_read_b64_tr_b16 v[92:93], v186 offset:8192
    v_mfma_f32_16x16x32_bf16 v[60:63], v[76:79], v[132:135], v[60:63]
    ds_read_b64_tr_b16 v[94:95], v186 offset:10240
    s_waitcnt lgkmcnt(6)
    v_mfma_f32_16x16x32_bf16 v[64:67], v[80:83], v[128:131], v[64:67]
    ds_read_b64_tr_b16 v[72:73], v187 offset:8192
    v_mfma_f32_16x16x32_bf16 v[68:71], v[80:83], v[132:135], v[68:71]
    ds_read_b64_tr_b16 v[74:75], v187 offset:10240
    s_waitcnt lgkmcnt(6)
    v_mfma_f32_16x16x32_bf16 v[0:3], v[84:87], v[136:139], v[0:3]
    ds_read_b64_tr_b16 v[76:77], v188 offset:8192
    v_mfma_f32_16x16x32_bf16 v[4:7], v[84:87], v[140:143], v[4:7]
    ds_read_b64_tr_b16 v[78:79], v188 offset:10240
    s_waitcnt lgkmcnt(6)
    v_mfma_f32_16x16x32_bf16 v[8:11], v[88:91], v[136:139], v[8:11]
    ds_read_b64_tr_b16 v[80:81], v189 offset:8192
    v_mfma_f32_16x16x32_bf16 v[12:15], v[88:91], v[140:143], v[12:15]
    ds_read_b64_tr_b16 v[82:83], v189 offset:10240
    s_waitcnt lgkmcnt(6)
    v_mfma_f32_16x16x32_bf16 v[16:19], v[92:95], v[136:139], v[16:19]
    ds_read_b64_tr_b16 v[84:85], v190 offset:8192
    v_mfma_f32_16x16x32_bf16 v[20:23], v[92:95], v[140:143], v[20:23]
    ds_read_b64_tr_b16 v[86:87], v190 offset:10240
    s_waitcnt lgkmcnt(6)
    v_mfma_f32_16x16x32_bf16 v[24:27], v[72:75], v[136:139], v[24:27]
    ds_read_b64_tr_b16 v[88:89], v191 offset:8192
    v_mfma_f32_16x16x32_bf16 v[28:31], v[72:75], v[140:143], v[28:31]
    ds_read_b64_tr_b16 v[90:91], v191 offset:10240
    s_waitcnt lgkmcnt(6)
    v_mfma_f32_16x16x32_bf16 v[32:35], v[76:79], v[136:139], v[32:35]
    ds_read_b64_tr_b16 v[92:93], v193 offset:1024
    v_mfma_f32_16x16x32_bf16 v[36:39], v[76:79], v[140:143], v[36:39]
    ds_read_b64_tr_b16 v[94:95], v193 offset:1280
    s_waitcnt lgkmcnt(6)
    v_mfma_f32_16x16x32_bf16 v[40:43], v[80:83], v[136:139], v[40:43]
    v_mfma_f32_16x16x32_bf16 v[44:47], v[80:83], v[140:143], v[44:47]
    s_waitcnt lgkmcnt(4)
    v_mfma_f32_16x16x32_bf16 v[48:51], v[84:87], v[136:139], v[48:51]
    v_mfma_f32_16x16x32_bf16 v[52:55], v[84:87], v[140:143], v[52:55]
    s_waitcnt lgkmcnt(2)
    v_mfma_f32_16x16x32_bf16 v[56:59], v[88:91], v[136:139], v[56:59]
    v_mfma_f32_16x16x32_bf16 v[60:63], v[88:91], v[140:143], v[60:63]
    s_waitcnt lgkmcnt(0)
    v_mfma_f32_16x16x32_bf16 v[64:67], v[92:95], v[136:139], v[64:67]
    v_mfma_f32_16x16x32_bf16 v[68:71], v[92:95], v[140:143], v[68:71]
    s_branch L_p2_done
L_p2:
    v_xor_b32 v176, 0, v160
    v_add_u32 v184, 73728, v176
    v_xor_b32 v177, 32, v160
    v_add_u32 v185, 73728, v177
    v_xor_b32 v178, 64, v160
    v_add_u32 v186, 73728, v178
    v_xor_b32 v179, 96, v160
    v_add_u32 v187, 73728, v179
    v_xor_b32 v180, 128, v160
    v_add_u32 v188, 73728, v180
    v_xor_b32 v181, 160, v160
    v_add_u32 v189, 73728, v181
    v_xor_b32 v182, 192, v160
    v_add_u32 v190, 73728, v182
    v_xor_b32 v183, 224, v160
    v_add_u32 v191, 73728, v183
    v_mov_b32 v192, v166
    v_add_u32 v193, 73728, v166
    s_add_u32 s95, s53, 18432
    ds_read_b64_tr_b16 v[72:73], v184 offset:16384
    ds_read_b64_tr_b16 v[74:75], v184 offset:18432
    ds_read_b64_tr_b16 v[76:77], v185 offset:16384
    ds_read_b64_tr_b16 v[78:79], v185 offset:18432
    ds_read_b64_tr_b16 v[80:81], v186 offset:16384
    ds_read_b64_tr_b16 v[82:83], v186 offset:18432
    ds_read_b64_tr_b16 v[84:85], v187 offset:16384
    ds_read_b64_tr_b16 v[86:87], v187 offset:18432
    s_waitcnt vmcnt(8)
    s_waitcnt lgkmcnt(6)
    v_mfma_f32_16x16x32_bf16 v[0:3], v[72:75], v[128:131], 0
    ds_read_b64_tr_b16 v[88:89], v188 offset:16384
    v_mfma_f32_16x16x32_bf16 v[4:7], v[72:75], v[132:135], 0
    ds_read_b64_tr_b16 v[90:91], v188 offset:18432
    s_waitcnt lgkmcnt(6)
    v_mfma_f32_16x16x32_bf16 v[8:11], v[76:79], v[128:131], 0
    ds_read_b64_tr_b16 v[92:93], v189 offset:16384
    v_mfma_f32_16x16x32_bf16 v[12:15], v[76:79], v[132:135], 0
    ds_read_b64_tr_b16 v[94:95], v189 offset:18432
    s_add_u32 s39, s53, 43008
    buffer_load_dwordx4 v[144:147], v165, s[20:23], s39 offen offset:0 sc1
    s_waitcnt lgkmcnt(6)
    v_mfma_f32_16x16x32_bf16 v[16:19], v[80:83], v[128:131], 0
    ds_read_b64_tr_b16 v[72:73], v190 offset:16384
    v_mfma_f32_16x16x32_bf16 v[20:23], v[80:83], v[132:135], 0
    ds_read_b64_tr_b16 v[74:75], v190 offset:18432
    buffer_load_dwordx4 v[148:151], v165, s[20:23], s39 offen offset:1024 sc1
    s_waitcnt lgkmcnt(6)
    v_mfma_f32_16x16x32_bf16 v[24:27], v[84:87], v[128:131], 0
    ds_read_b64_tr_b16 v[76:77], v191 offset:16384
    v_mfma_f32_16x16x32_bf16 v[28:31], v[84:87], v[132:135], 0
    ds_read_b64_tr_b16 v[78:79], v191 offset:18432
    s_add_u32 s39, s95, 43008
    buffer_load_dwordx4 v[152:155], v165, s[20:23], s39 offen offset:0 sc1
    s_waitcnt lgkmcnt(6)
    v_mfma_f32_16x16x32_bf16 v[32:35], v[88:91], v[128:131], 0
    ds_read_b64_tr_b16 v[80:81], v193 offset:2048
    v_mfma_f32_16x16x32_bf16 v[36:39], v[88:91], v[132:135], 0
    ds_read_b64_tr_b16 v[82:83], v193 offset:2304
    buffer_load_dwordx4 v[156:159], v165, s[20:23], s39 offen offset:1024 sc1
    s_waitcnt lgkmcnt(6)
    v_mfma_f32_16x16x32_bf16 v[40:43], v[92:95], v[128:131], 0
    ds_read_b64_tr_b16 v[84:85], v184 offset:24576
    v_mfma_f32_16x16x32_bf16 v[44:47], v[92:95], v[132:135], 0
    ds_read_b64_tr_b16 v[86:87], v184 offset:26624
    s_waitcnt lgkmcnt(6)
    v_mfma_f32_16x16x32_bf16 v[48:51], v[72:75], v[128:131], 0
    ds_read_b64_tr_b16 v[88:89], v185 offset:24576
    v_mfma_f32_16x16x32_bf16 v[52:55], v[72:75], v[132:135], 0
    ds_read_b64_tr_b16 v[90:91], v185 offset:26624
    s_add_u32 s39, s53, 6144
    buffer_load_dwordx4 v[112:115], v165, s[20:23], s39 offen offset:0 sc1
    s_waitcnt lgkmcnt(6)
    v_mfma_f32_16x16x32_bf16 v[56:59], v[76:79], v[128:131], 0
    ds_read_b64_tr_b16 v[92:93], v186 offset:24576
    v_mfma_f32_16x16x32_bf16 v[60:63], v[76:79], v[132:135], 0
    ds_read_b64_tr_b16 v[94:95], v186 offset:26624
    buffer_load_dwordx4 v[116:119], v165, s[20:23], s39 offen offset:1024 sc1
    s_waitcnt lgkmcnt(6)
    v_mfma_f32_16x16x32_bf16 v[64:67], v[80:83], v[128:131], 0
    ds_read_b64_tr_b16 v[72:73], v187 offset:24576
    v_mfma_f32_16x16x32_bf16 v[68:71], v[80:83], v[132:135], 0
    ds_read_b64_tr_b16 v[74:75], v187 offset:26624
    s_add_u32 s39, s95, 6144
    buffer_load_dwordx4 v[120:123], v165, s[20:23], s39 offen offset:0 sc1
    s_waitcnt lgkmcnt(6)
    v_mfma_f32_16x16x32_bf16 v[0:3], v[84:87], v[136:139], v[0:3]
    ds_read_b64_tr_b16 v[76:77], v188 offset:24576
    v_mfma_f32_16x16x32_bf16 v[4:7], v[84:87], v[140:143], v[4:7]
    ds_read_b64_tr_b16 v[78:79], v188 offset:26624
    buffer_load_dwordx4 v[124:127], v165, s[20:23], s39 offen offset:1024 sc1
    s_waitcnt lgkmcnt(6)
    v_mfma_f32_16x16x32_bf16 v[8:11], v[88:91], v[136:139], v[8:11]
    ds_read_b64_tr_b16 v[80:81], v189 offset:24576
    v_mfma_f32_16x16x32_bf16 v[12:15], v[88:91], v[140:143], v[12:15]
    ds_read_b64_tr_b16 v[82:83], v189 offset:26624
    s_waitcnt lgkmcnt(6)
    v_mfma_f32_16x16x32_bf16 v[16:19], v[92:95], v[136:139], v[16:19]
    ds_read_b64_tr_b16 v[84:85], v190 offset:24576
    v_mfma_f32_16x16x32_bf16 v[20:23], v[92:95], v[140:143], v[20:23]
    ds_read_b64_tr_b16 v[86:87], v190 offset:26624
    s_waitcnt lgkmcnt(6)
    v_mfma_f32_16x16x32_bf16 v[24:27], v[72:75], v[136:139], v[24:27]
    ds_read_b64_tr_b16 v[88:89], v191 offset:24576
    v_mfma_f32_16x16x32_bf16 v[28:31], v[72:75], v[140:143], v[28:31]
    ds_read_b64_tr_b16 v[90:91], v191 offset:26624
    buffer_load_dword v163, v164, s[20:23], s60 offen sc1
    s_waitcnt lgkmcnt(6)
    v_mfma_f32_16x16x32_bf16 v[32:35], v[76:79], v[136:139], v[32:35]
    ds_read_b64_tr_b16 v[92:93], v193 offset:3072
    v_mfma_f32_16x16x32_bf16 v[36:39], v[76:79], v[140:143], v[36:39]
    ds_read_b64_tr_b16 v[94:95], v193 offset:3328
    s_waitcnt lgkmcnt(6)
    v_mfma_f32_16x16x32_bf16 v[40:43], v[80:83], v[136:139], v[40:43]
    ds_read_b64_tr_b16 v[72:73], v184 offset:0
    v_mfma_f32_16x16x32_bf16 v[44:47], v[80:83], v[140:143], v[44:47]
    ds_read_b64_tr_b16 v[74:75], v184 offset:2048
    s_waitcnt lgkmcnt(6)
    v_mfma_f32_16x16x32_bf16 v[48:51], v[84:87], v[136:139], v[48:51]
    ds_read_b64_tr_b16 v[76:77], v185 offset:0
    v_mfma_f32_16x16x32_bf16 v[52:55], v[84:87], v[140:143], v[52:55]
    ds_read_b64_tr_b16 v[78:79], v185 offset:2048
    s_waitcnt lgkmcnt(6)
    v_mfma_f32_16x16x32_bf16 v[56:59], v[88:91], v[136:139], v[56:59]
    ds_read_b64_tr_b16 v[80:81], v186 offset:0
    v_mfma_f32_16x16x32_bf16 v[60:63], v[88:91], v[140:143], v[60:63]
    ds_read_b64_tr_b16 v[82:83], v186 offset:2048
    s_waitcnt lgkmcnt(6)
    v_mfma_f32_16x16x32_bf16 v[64:67], v[92:95], v[136:139], v[64:67]
    ds_read_b64_tr_b16 v[84:85], v187 offset:0
    v_mfma_f32_16x16x32_bf16 v[68:71], v[92:95], v[140:143], v[68:71]
    ds_read_b64_tr_b16 v[86:87], v187 offset:2048
    s_waitcnt vmcnt(11)
    s_waitcnt lgkmcnt(6)
    v_mfma_f32_16x16x32_bf16 v[0:3], v[72:75], v[96:99], v[0:3]
    ds_read_b64_tr_b16 v[88:89], v188 offset:0
    v_mfma_f32_16x16x32_bf16 v[4:7], v[72:75], v[100:103], v[4:7]
    ds_read_b64_tr_b16 v[90:91], v188 offset:2048
    s_waitcnt lgkmcnt(6)
    v_mfma_f32_16x16x32_bf16 v[8:11], v[76:79], v[96:99], v[8:11]
    ds_read_b64_tr_b16 v[92:93], v189 offset:0
    v_mfma_f32_16x16x32_bf16 v[12:15], v[76:79], v[100:103], v[12:15]
    ds_read_b64_tr_b16 v[94:95], v189 offset:2048
    s_waitcnt lgkmcnt(6)
    v_mfma_f32_16x16x32_bf16 v[16:19], v[80:83], v[96:99], v[16:19]
    ds_read_b64_tr_b16 v[72:73], v190 offset:0
    v_mfma_f32_16x16x32_bf16 v[20:23], v[80:83], v[100:103], v[20:23]
    ds_read_b64_tr_b16 v[74:75], v190 offset:2048
    s_waitcnt vmcnt(10)
    v_lshlrev_b32 v168, 4, v243
    v_mov_b32 v169, s35
    v_cmp_gt_u32 vcc, 2, v243
    s_add_u32 s38, s47, 64
    s_and_saveexec_b64 s[58:59], vcc
    buffer_store_dword v169, v168, s[20:23], s38 offen sc1
    s_mov_b64 exec, s[58:59]
    s_waitcnt lgkmcnt(6)
    v_mfma_f32_16x16x32_bf16 v[24:27], v[84:87], v[96:99], v[24:27]
    ds_read_b64_tr_b16 v[76:77], v191 offset:0
    v_mfma_f32_16x16x32_bf16 v[28:31], v[84:87], v[100:103], v[28:31]
    ds_read_b64_tr_b16 v[78:79], v191 offset:2048
    s_waitcnt lgkmcnt(6)
    v_mfma_f32_16x16x32_bf16 v[32:35], v[88:91], v[96:99], v[32:35]
    ds_read_b64_tr_b16 v[80:81], v193 offset:0
    v_mfma_f32_16x16x32_bf16 v[36:39], v[88:91], v[100:103], v[36:39]
    ds_read_b64_tr_b16 v[82:83], v193 offset:256
    s_waitcnt lgkmcnt(6)
    v_mfma_f32_16x16x32_bf16 v[40:43], v[92:95], v[96:99], v[40:43]
    ds_read_b64_tr_b16 v[84:85], v184 offset:8192
    v_mfma_f32_16x16x32_bf16 v[44:47], v[92:95], v[100:103], v[44:47]
    ds_read_b64_tr_b16 v[86:87], v184 offset:10240
    s_waitcnt lgkmcnt(6)
    v_mfma_f32_16x16x32_bf16 v[48:51], v[72:75], v[96:99], v[48:51]
    ds_read_b64_tr_b16 v[88:89], v185 offset:8192
    v_mfma_f32_16x16x32_bf16 v[52:55], v[72:75], v[100:103], v[52:55]
    ds_read_b64_tr_b16 v[90:91], v185 offset:10240
    s_waitcnt lgkmcnt(6)
    v_mfma_f32_16x16x32_bf16 v[56:59], v[76:79], v[96:99], v[56:59]
    ds_read_b64_tr_b16 v[92:93], v186 offset:8192
    v_mfma_f32_16x16x32_bf16 v[60:63], v[76:79], v[100:103], v[60:63]
    ds_read_b64_tr_b16 v[94:95], v186 offset:10240
    s_waitcnt lgkmcnt(6)
    v_mfma_f32_16x16x32_bf16 v[64:67], v[80:83], v[96:99], v[64:67]
    ds_read_b64_tr_b16 v[72:73], v187 offset:8192
    v_mfma_f32_16x16x32_bf16 v[68:71], v[80:83], v[100:103], v[68:71]
    ds_read_b64_tr_b16 v[74:75], v187 offset:10240
    s_waitcnt lgkmcnt(6)
    v_mfma_f32_16x16x32_bf16 v[0:3], v[84:87], v[104:107], v[0:3]
    ds_read_b64_tr_b16 v[76:77], v188 offset:8192
    v_mfma_f32_16x16x32_bf16 v[4:7], v[84:87], v[108:111], v[4:7]
    ds_read_b64_tr_b16 v[78:79], v188 offset:10240
    s_waitcnt vmcnt(1)
    v_cmp_ne_u32 vcc, s35, v163
    s_and_b32 s38, vcc_lo, 0xff
    s_cbranch_scc0 L_ok_4
    s_mov_b32 s61, 0
L_spin_4:
    buffer_load_dword v163, v164, s[20:23], s60 offen sc1
    s_add_u32 s61, s61, 1
    s_cmp_gt_u32 s61, 200000
    s_cbranch_scc1 L_ok_4
    s_waitcnt vmcnt(0)
    v_cmp_ne_u32 vcc, s35, v163
    s_and_b32 s38, vcc_lo, 0xff
    s_cbranch_scc1 L_spin_4
L_ok_4:
    s_waitcnt lgkmcnt(6)
    v_mfma_f32_16x16x32_bf16 v[8:11], v[88:91], v[104:107], v[8:11]
    ds_read_b64_tr_b16 v[80:81], v189 offset:8192
    v_mfma_f32_16x16x32_bf16 v[12:15], v[88:91], v[108:111], v[12:15]
    ds_read_b64_tr_b16 v[82:83], v189 offset:10240
    s_add_u32 s39, s53, 0
    buffer_load_dwordx4 v[128:131], v165, s[20:23], s39 offen offset:0 sc1
    s_waitcnt lgkmcnt(6)
    v_mfma_f32_16x16x32_bf16 v[16:19], v[92:95], v[104:107], v[16:19]
    ds_read_b64_tr_b16 v[84:85], v190 offset:8192
    v_mfma_f32_16x16x32_bf16 v[20:23], v[92:95], v[108:111], v[20:23]
    ds_read_b64_tr_b16 v[86:87], v190 offset:10240
    buffer_load_dwordx4 v[132:135], v165, s[20:23], s39 offen offset:1024 sc1
    s_waitcnt lgkmcnt(6)
    v_mfma_f32_16x16x32_bf16 v[24:27], v[72:75], v[104:107], v[24:27]
    ds_read_b64_tr_b16 v[88:89], v191 offset:8192
    v_mfma_f32_16x16x32_bf16 v[28:31], v[72:75], v[108:111], v[28:31]
    ds_read_b64_tr_b16 v[90:91], v191 offset:10240
    s_add_u32 s39, s95, 0
    buffer_load_dwordx4 v[136:139], v165, s[20:23], s39 offen offset:0 sc1
    s_waitcnt lgkmcnt(6)
    v_mfma_f32_16x16x32_bf16 v[32:35], v[76:79], v[104:107], v[32:35]
    ds_read_b64_tr_b16 v[92:93], v193 offset:1024
    v_mfma_f32_16x16x32_bf16 v[36:39], v[76:79], v[108:111], v[36:39]
    ds_read_b64_tr_b16 v[94:95], v193 offset:1280
    buffer_load_dwordx4 v[140:143], v165, s[20:23], s39 offen offset:1024 sc1
    s_barrier
    s_waitcnt lgkmcnt(6)
    v_mfma_f32_16x16x32_bf16 v[40:43], v[80:83], v[104:107], v[40:43]
    ds_read_b64_tr_b16 v[72:73], v184 offset:53248
    v_mfma_f32_16x16x32_bf16 v[44:47], v[80:83], v[108:111], v[44:47]
    ds_read_b64_tr_b16 v[74:75], v184 offset:55296
    s_waitcnt lgkmcnt(6)
    v_mfma_f32_16x16x32_bf16 v[48:51], v[84:87], v[104:107], v[48:51]
    ds_read_b64_tr_b16 v[76:77], v185 offset:53248
    v_mfma_f32_16x16x32_bf16 v[52:55], v[84:87], v[108:111], v[52:55]
    ds_read_b64_tr_b16 v[78:79], v185 offset:55296
    s_waitcnt lgkmcnt(6)
    v_mfma_f32_16x16x32_bf16 v[56:59], v[88:91], v[104:107], v[56:59]
    ds_read_b64_tr_b16 v[80:81], v186 offset:53248
    v_mfma_f32_16x16x32_bf16 v[60:63], v[88:91], v[108:111], v[60:63]
    ds_read_b64_tr_b16 v[82:83], v186 offset:55296
    s_waitcnt lgkmcnt(6)
    v_mfma_f32_16x16x32_bf16 v[64:67], v[92:95], v[104:107], v[64:67]
    ds_read_b64_tr_b16 v[84:85], v187 offset:53248
    v_mfma_f32_16x16x32_bf16 v[68:71], v[92:95], v[108:111], v[68:71]
    ds_read_b64_tr_b16 v[86:87], v187 offset:55296
    s_waitcnt lgkmcnt(6)
    v_mfma_f32_16x16x32_bf16 v[0:3], v[72:75], v[144:147], v[0:3]
    ds_read_b64_tr_b16 v[88:89], v188 offset:53248
    v_mfma_f32_16x16x32_bf16 v[4:7], v[72:75], v[148:151], v[4:7]
    ds_read_b64_tr_b16 v[90:91], v188 offset:55296
    s_waitcnt lgkmcnt(6)
    v_mfma_f32_16x16x32_bf16 v[8:11], v[76:79], v[144:147], v[8:11]
    ds_read_b64_tr_b16 v[92:93], v189 offset:53248
    v_mfma_f32_16x16x32_bf16 v[12:15], v[76:79], v[148:151], v[12:15]
    ds_read_b64_tr_b16 v[94:95], v189 offset:55296
    s_add_u32 s39, s53, 36864
    buffer_load_dwordx4 v[96:99], v165, s[20:23], s39 offen offset:0 sc1
    s_waitcnt lgkmcnt(6)
    v_mfma_f32_16x16x32_bf16 v[16:19], v[80:83], v[144:147], v[16:19]
    ds_read_b64_tr_b16 v[72:73], v190 offset:53248
    v_mfma_f32_16x16x32_bf16 v[20:23], v[80:83], v[148:151], v[20:23]
    ds_read_b64_tr_b16 v[74:75], v190 offset:55296
    buffer_load_dwordx4 v[100:103], v165, s[20:23], s39 offen offset:1024 sc1
    s_waitcnt lgkmcnt(6)
    v_mfma_f32_16x16x32_bf16 v[24:27], v[84:87], v[144:147], v[24:27]
    ds_read_b64_tr_b16 v[76:77], v191 offset:53248
    v_mfma_f32_16x16x32_bf16 v[28:31], v[84:87], v[148:151], v[28:31]
    ds_read_b64_tr_b16 v[78:79], v191 offset:55296
    s_add_u32 s39, s95, 36864
    buffer_load_dwordx4 v[104:107], v165, s[20:23], s39 offen offset:0 sc1
    s_waitcnt lgkmcnt(6)
    v_mfma_f32_16x16x32_bf16 v[32:35], v[88:91], v[144:147], v[32:35]
    ds_read_b64_tr_b16 v[80:81], v193 offset:38912
    v_mfma_f32_16x16x32_bf16 v[36:39], v[88:91], v[148:151], v[36:39]
    ds_read_b64_tr_b16 v[82:83], v193 offset:39168
    buffer_load_dwordx4 v[108:111], v165, s[20:23], s39 offen offset:1024 sc1
    s_waitcnt lgkmcnt(6)
    v_mfma_f32_16x16x32_bf16 v[40:43], v[92:95], v[144:147], v[40:43]
    ds_read_b64_tr_b16 v[84:85], v184 offset:61440
    v_mfma_f32_16x16x32_bf16 v[44:47], v[92:95], v[148:151], v[44:47]
    ds_read_b64_tr_b16 v[86:87], v184 offset:63488
    s_add_u32 m0, s62, 36864
    s_add_u32 s40, s54, 36864
    buffer_load_dwordx4 v232, s[12:15], s40 offen lds
    s_waitcnt lgkmcnt(6)
    v_mfma_f32_16x16x32_bf16 v[48:51], v[72:75], v[144:147], v[48:51]
    ds_read_b64_tr_b16 v[88:89], v185 offset:61440
    v_mfma_f32_16x16x32_bf16 v[52:55], v[72:75], v[148:151], v[52:55]
    ds_read_b64_tr_b16 v[90:91], v185 offset:63488
    s_add_u32 m0, s62, 45056
    s_add_u32 s40, s54, 405504
    buffer_load_dwordx4 v232, s[12:15], s40 offen lds
    s_waitcnt lgkmcnt(6)
    v_mfma_f32_16x16x32_bf16 v[56:59], v[76:79], v[144:147], v[56:59]
    ds_read_b64_tr_b16 v[92:93], v186 offset:61440
    v_mfma_f32_16x16x32_bf16 v[60:63], v[76:79], v[148:151], v[60:63]
    ds_read_b64_tr_b16 v[94:95], v186 offset:63488
    s_add_u32 m0, s62, 53248
    s_add_u32 s40, s54, 700416
    buffer_load_dwordx4 v232, s[12:15], s40 offen lds
    s_waitcnt lgkmcnt(6)
    v_mfma_f32_16x16x32_bf16 v[64:67], v[80:83], v[144:147], v[64:67]
    ds_read_b64_tr_b16 v[72:73], v187 offset:61440
    v_mfma_f32_16x16x32_bf16 v[68:71], v[80:83], v[148:151], v[68:71]
    ds_read_b64_tr_b16 v[74:75], v187 offset:63488
    s_add_u32 m0, s62, 61440
    s_add_u32 s40, s54, 1069056
    buffer_load_dwordx4 v232, s[12:15], s40 offen lds
    s_waitcnt lgkmcnt(6)
    v_mfma_f32_16x16x32_bf16 v[0:3], v[84:87], v[152:155], v[0:3]
    ds_read_b64_tr_b16 v[76:77], v188 offset:61440
    v_mfma_f32_16x16x32_bf16 v[4:7], v[84:87], v[156:159], v[4:7]
    ds_read_b64_tr_b16 v[78:79], v188 offset:63488
    s_add_u32 m0, s62, 69632
    s_and_b32 s40, s33, 1
    s_mul_i32 s40, s40, 36864
    s_add_u32 s40, s40, s55
    s_add_u32 s40, s40, 36864
    buffer_load_dwordx4 v234, s[12:15], s40 offen lds
    s_waitcnt lgkmcnt(6)
    v_mfma_f32_16x16x32_bf16 v[8:11], v[88:91], v[152:155], v[8:11]
    ds_read_b64_tr_b16 v[80:81], v189 offset:61440
    v_mfma_f32_16x16x32_bf16 v[12:15], v[88:91], v[156:159], v[12:15]
    ds_read_b64_tr_b16 v[82:83], v189 offset:63488
    s_waitcnt lgkmcnt(6)
    v_mfma_f32_16x16x32_bf16 v[16:19], v[92:95], v[152:155], v[16:19]
    ds_read_b64_tr_b16 v[84:85], v190 offset:61440
    v_mfma_f32_16x16x32_bf16 v[20:23], v[92:95], v[156:159], v[20:23]
    ds_read_b64_tr_b16 v[86:87], v190 offset:63488
    s_waitcnt lgkmcnt(6)
    v_mfma_f32_16x16x32_bf16 v[24:27], v[72:75], v[152:155], v[24:27]
    ds_read_b64_tr_b16 v[88:89], v191 offset:61440
    v_mfma_f32_16x16x32_bf16 v[28:31], v[72:75], v[156:159], v[28:31]
    ds_read_b64_tr_b16 v[90:91], v191 offset:63488
    s_waitcnt lgkmcnt(6)
    v_mfma_f32_16x16x32_bf16 v[32:35], v[76:79], v[152:155], v[32:35]
    ds_read_b64_tr_b16 v[92:93], v193 offset:39936
    v_mfma_f32_16x16x32_bf16 v[36:39], v[76:79], v[156:159], v[36:39]
    ds_read_b64_tr_b16 v[94:95], v193 offset:40192
    s_waitcnt lgkmcnt(6)
    v_mfma_f32_16x16x32_bf16 v[40:43], v[80:83], v[152:155], v[40:43]
    ds_read_b64_tr_b16 v[72:73], v184 offset:36864
    v_mfma_f32_16x16x32_bf16 v[44:47], v[80:83], v[156:159], v[44:47]
    ds_read_b64_tr_b16 v[74:75], v184 offset:38912
    s_waitcnt lgkmcnt(6)
    v_mfma_f32_16x16x32_bf16 v[48:51], v[84:87], v[152:155], v[48:51]
    ds_read_b64_tr_b16 v[76:77], v185 offset:36864
    v_mfma_f32_16x16x32_bf16 v[52:55], v[84:87], v[156:159], v[52:55]
    ds_read_b64_tr_b16 v[78:79], v185 offset:38912
    s_waitcnt lgkmcnt(6)
    v_mfma_f32_16x16x32_bf16 v[56:59], v[88:91], v[152:155], v[56:59]
    ds_read_b64_tr_b16 v[80:81], v186 offset:36864
    v_mfma_f32_16x16x32_bf16 v[60:63], v[88:91], v[156:159], v[60:63]
    ds_read_b64_tr_b16 v[82:83], v186 offset:38912
    s_waitcnt lgkmcnt(6)
    v_mfma_f32_16x16x32_bf16 v[64:67], v[92:95], v[152:155], v[64:67]
    ds_read_b64_tr_b16 v[84:85], v187 offset:36864
    v_mfma_f32_16x16x32_bf16 v[68:71], v[92:95], v[156:159], v[68:71]
    ds_read_b64_tr_b16 v[86:87], v187 offset:38912
    s_waitcnt lgkmcnt(6)
    v_mfma_f32_16x16x32_bf16 v[0:3], v[72:75], v[112:115], v[0:3]
    ds_read_b64_tr_b16 v[88:89], v188 offset:36864
    v_mfma_f32_16x16x32_bf16 v[4:7], v[72:75], v[116:119], v[4:7]
    ds_read_b64_tr_b16 v[90:91], v188 offset:38912
    s_waitcnt lgkmcnt(6)
    v_mfma_f32_16x16x32_bf16 v[8:11], v[76:79], v[112:115], v[8:11]
    ds_read_b64_tr_b16 v[92:93], v189 offset:36864
    v_mfma_f32_16x16x32_bf16 v[12:15], v[76:79], v[116:119], v[12:15]
    ds_read_b64_tr_b16 v[94:95], v189 offset:38912
    s_add_u32 s39, s53, 2048
    buffer_load_dwordx4 v[144:147], v165, s[20:23], s39 offen offset:0 sc1
    s_waitcnt lgkmcnt(6)
    v_mfma_f32_16x16x32_bf16 v[16:19], v[80:83], v[112:115], v[16:19]
    ds_read_b64_tr_b16 v[72:73], v190 offset:36864
    v_mfma_f32_16x16x32_bf16 v[20:23], v[80:83], v[116:119], v[20:23]
    ds_read_b64_tr_b16 v[74:75], v190 offset:38912
    buffer_load_dwordx4 v[148:151], v165, s[20:23], s39 offen offset:1024 sc1
    s_waitcnt lgkmcnt(6)
    v_mfma_f32_16x16x32_bf16 v[24:27], v[84:87], v[112:115], v[24:27]
    ds_read_b64_tr_b16 v[76:77], v191 offset:36864
    v_mfma_f32_16x16x32_bf16 v[28:31], v[84:87], v[116:119], v[28:31]
    ds_read_b64_tr_b16 v[78:79], v191 offset:38912
    s_add_u32 s39, s95, 2048
    buffer_load_dwordx4 v[152:155], v165, s[20:23], s39 offen offset:0 sc1
    s_waitcnt lgkmcnt(6)
    v_mfma_f32_16x16x32_bf16 v[32:35], v[88:91], v[112:115], v[32:35]
    ds_read_b64_tr_b16 v[80:81], v193 offset:36864
    v_mfma_f32_16x16x32_bf16 v[36:39], v[88:91], v[116:119], v[36:39]
    ds_read_b64_tr_b16 v[82:83], v193 offset:37120
    buffer_load_dwordx4 v[156:159], v165, s[20:23], s39 offen offset:1024 sc1
    s_waitcnt lgkmcnt(6)
    v_mfma_f32_16x16x32_bf16 v[40:43], v[92:95], v[112:115], v[40:43]
    ds_read_b64_tr_b16 v[84:85], v184 offset:45056
    v_mfma_f32_16x16x32_bf16 v[44:47], v[92:95], v[116:119], v[44:47]
    ds_read_b64_tr_b16 v[86:87], v184 offset:47104
    s_waitcnt lgkmcnt(6)
    v_mfma_f32_16x16x32_bf16 v[48:51], v[72:75], v[112:115], v[48:51]
    ds_read_b64_tr_b16 v[88:89], v185 offset:45056
    v_mfma_f32_16x16x32_bf16 v[52:55], v[72:75], v[116:119], v[52:55]
    ds_read_b64_tr_b16 v[90:91], v185 offset:47104
    s_waitcnt lgkmcnt(6)
    v_mfma_f32_16x16x32_bf16 v[56:59], v[76:79], v[112:115], v[56:59]
    ds_read_b64_tr_b16 v[92:93], v186 offset:45056
    v_mfma_f32_16x16x32_bf16 v[60:63], v[76:79], v[116:119], v[60:63]
    ds_read_b64_tr_b16 v[94:95], v186 offset:47104
    s_waitcnt lgkmcnt(6)
    v_mfma_f32_16x16x32_bf16 v[64:67], v[80:83], v[112:115], v[64:67]
    ds_read_b64_tr_b16 v[72:73], v187 offset:45056
    v_mfma_f32_16x16x32_bf16 v[68:71], v[80:83], v[116:119], v[68:71]
    ds_read_b64_tr_b16 v[74:75], v187 offset:47104
    buffer_load_dword v163, v164, s[20:23], s60 offen sc1
    s_waitcnt lgkmcnt(6)
    v_mfma_f32_16x16x32_bf16 v[0:3], v[84:87], v[120:123], v[0:3]
    ds_read_b64_tr_b16 v[76:77], v188 offset:45056
    v_mfma_f32_16x16x32_bf16 v[4:7], v[84:87], v[124:127], v[4:7]
    ds_read_b64_tr_b16 v[78:79], v188 offset:47104
    s_waitcnt lgkmcnt(6)
    v_mfma_f32_16x16x32_bf16 v[8:11], v[88:91], v[120:123], v[8:11]
    ds_read_b64_tr_b16 v[80:81], v189 offset:45056
    v_mfma_f32_16x16x32_bf16 v[12:15], v[88:91], v[124:127], v[12:15]
    ds_read_b64_tr_b16 v[82:83], v189 offset:47104
    s_waitcnt lgkmcnt(6)
    v_mfma_f32_16x16x32_bf16 v[16:19], v[92:95], v[120:123], v[16:19]
    ds_read_b64_tr_b16 v[84:85], v190 offset:45056
    v_mfma_f32_16x16x32_bf16 v[20:23], v[92:95], v[124:127], v[20:23]
    ds_read_b64_tr_b16 v[86:87], v190 offset:47104
    s_waitcnt lgkmcnt(6)
    v_mfma_f32_16x16x32_bf16 v[24:27], v[72:75], v[120:123], v[24:27]
    ds_read_b64_tr_b16 v[88:89], v191 offset:45056
    v_mfma_f32_16x16x32_bf16 v[28:31], v[72:75], v[124:127], v[28:31]
    ds_read_b64_tr_b16 v[90:91], v191 offset:47104
    s_waitcnt lgkmcnt(6)
    v_mfma_f32_16x16x32_bf16 v[32:35], v[76:79], v[120:123], v[32:35]
    ds_read_b64_tr_b16 v[92:93], v193 offset:37888
    v_mfma_f32_16x16x32_bf16 v[36:39], v[76:79], v[124:127], v[36:39]
    ds_read_b64_tr_b16 v[94:95], v193 offset:38144
    s_barrier
    s_waitcnt lgkmcnt(6)
    v_mfma_f32_16x16x32_bf16 v[40:43], v[80:83], v[120:123], v[40:43]
    ds_read_b64_tr_b16 v[72:73], v176 offset:16384
    v_mfma_f32_16x16x32_bf16 v[44:47], v[80:83], v[124:127], v[44:47]
    ds_read_b64_tr_b16 v[74:75], v176 offset:18432
    s_waitcnt lgkmcnt(6)
    v_mfma_f32_16x16x32_bf16 v[48:51], v[84:87], v[120:123], v[48:51]
    ds_read_b64_tr_b16 v[76:77], v177 offset:16384
    v_mfma_f32_16x16x32_bf16 v[52:55], v[84:87], v[124:127], v[52:55]
    ds_read_b64_tr_b16 v[78:79], v177 offset:18432
    s_waitcnt lgkmcnt(6)
    v_mfma_f32_16x16x32_bf16 v[56:59], v[88:91], v[120:123], v[56:59]
    ds_read_b64_tr_b16 v[80:81], v178 offset:16384
    v_mfma_f32_16x16x32_bf16 v[60:63], v[88:91], v[124:127], v[60:63]
    ds_read_b64_tr_b16 v[82:83], v178 offset:18432
    s_waitcnt lgkmcnt(6)
    v_mfma_f32_16x16x32_bf16 v[64:67], v[92:95], v[120:123], v[64:67]
    ds_read_b64_tr_b16 v[84:85], v179 offset:16384
    v_mfma_f32_16x16x32_bf16 v[68:71], v[92:95], v[124:127], v[68:71]
    ds_read_b64_tr_b16 v[86:87], v179 offset:18432
    s_waitcnt vmcnt(10)
    s_waitcnt lgkmcnt(6)
    v_mfma_f32_16x16x32_bf16 v[0:3], v[72:75], v[96:99], v[0:3]
    ds_read_b64_tr_b16 v[88:89], v180 offset:16384
    v_mfma_f32_16x16x32_bf16 v[4:7], v[72:75], v[100:103], v[4:7]
    ds_read_b64_tr_b16 v[90:91], v180 offset:18432
    s_waitcnt vmcnt(0)
    v_cmp_ne_u32 vcc, s35, v163
    s_and_b32 s38, vcc_lo, 0xff0000
    s_cbranch_scc0 L_ok_5
    s_mov_b32 s61, 0
L_spin_5:
    buffer_load_dword v163, v164, s[20:23], s60 offen sc1
    s_add_u32 s61, s61, 1
    s_cmp_gt_u32 s61, 200000
    s_cbranch_scc1 L_ok_5
    s_waitcnt vmcnt(0)
    v_cmp_ne_u32 vcc, s35, v163
    s_and_b32 s38, vcc_lo, 0xff0000
    s_cbranch_scc1 L_spin_5
L_ok_5:
    s_waitcnt lgkmcnt(6)
    v_mfma_f32_16x16x32_bf16 v[8:11], v[76:79], v[96:99], v[8:11]
    ds_read_b64_tr_b16 v[92:93], v181 offset:16384
    v_mfma_f32_16x16x32_bf16 v[12:15], v[76:79], v[100:103], v[12:15]
    ds_read_b64_tr_b16 v[94:95], v181 offset:18432
    s_add_u32 s39, s53, 8192
    buffer_load_dwordx4 v[112:115], v165, s[20:23], s39 offen offset:0 sc1
    s_waitcnt lgkmcnt(6)
    v_mfma_f32_16x16x32_bf16 v[16:19], v[80:83], v[96:99], v[16:19]
    ds_read_b64_tr_b16 v[72:73], v182 offset:16384
    v_mfma_f32_16x16x32_bf16 v[20:23], v[80:83], v[100:103], v[20:23]
    ds_read_b64_tr_b16 v[74:75], v182 offset:18432
    buffer_load_dwordx4 v[116:119], v165, s[20:23], s39 offen offset:1024 sc1
    s_waitcnt lgkmcnt(6)
    v_mfma_f32_16x16x32_bf16 v[24:27], v[84:87], v[96:99], v[24:27]
    ds_read_b64_tr_b16 v[76:77], v183 offset:16384
    v_mfma_f32_16x16x32_bf16 v[28:31], v[84:87], v[100:103], v[28:31]
    ds_read_b64_tr_b16 v[78:79], v183 offset:18432
    s_add_u32 s39, s95, 8192
    buffer_load_dwordx4 v[120:123], v165, s[20:23], s39 offen offset:0 sc1
    s_waitcnt lgkmcnt(6)
    v_mfma_f32_16x16x32_bf16 v[32:35], v[88:91], v[96:99], v[32:35]
    ds_read_b64_tr_b16 v[80:81], v192 offset:2048
    v_mfma_f32_16x16x32_bf16 v[36:39], v[88:91], v[100:103], v[36:39]
    ds_read_b64_tr_b16 v[82:83], v192 offset:2304
    buffer_load_dwordx4 v[124:127], v165, s[20:23], s39 offen offset:1024 sc1
    s_waitcnt lgkmcnt(6)
    v_mfma_f32_16x16x32_bf16 v[40:43], v[92:95], v[96:99], v[40:43]
    ds_read_b64_tr_b16 v[84:85], v176 offset:24576
    v_mfma_f32_16x16x32_bf16 v[44:47], v[92:95], v[100:103], v[44:47]
    ds_read_b64_tr_b16 v[86:87], v176 offset:26624
    s_add_u32 m0, s62, 73728
    s_add_u32 s40, s54, 147456
    buffer_load_dwordx4 v232, s[12:15], s40 offen lds
    s_waitcnt lgkmcnt(6)
    v_mfma_f32_16x16x32_bf16 v[48:51], v[72:75], v[96:99], v[48:51]
    ds_read_b64_tr_b16 v[88:89], v177 offset:24576
    v_mfma_f32_16x16x32_bf16 v[52:55], v[72:75], v[100:103], v[52:55]
    ds_read_b64_tr_b16 v[90:91], v177 offset:26624
    s_add_u32 m0, s62, 81920
    s_add_u32 s40, s54, 516096
    buffer_load_dwordx4 v232, s[12:15], s40 offen lds
    s_waitcnt lgkmcnt(6)
    v_mfma_f32_16x16x32_bf16 v[56:59], v[76:79], v[96:99], v[56:59]
    ds_read_b64_tr_b16 v[92:93], v178 offset:24576
    v_mfma_f32_16x16x32_bf16 v[60:63], v[76:79], v[100:103], v[60:63]
    ds_read_b64_tr_b16 v[94:95], v178 offset:26624
    s_add_u32 m0, s62, 90112
    s_add_u32 s40, s54, 811008
    buffer_load_dwordx4 v232, s[12:15], s40 offen lds
    s_waitcnt lgkmcnt(6)
    v_mfma_f32_16x16x32_bf16 v[64:67], v[80:83], v[96:99], v[64:67]
    ds_read_b64_tr_b16 v[72:73], v179 offset:24576
    v_mfma_f32_16x16x32_bf16 v[68:71], v[80:83], v[100:103], v[68:71]
    ds_read_b64_tr_b16 v[74:75], v179 offset:26624
    s_add_u32 m0, s62, 98304
    s_add_u32 s40, s54, 1179648
    buffer_load_dwordx4 v232, s[12:15], s40 offen lds
    s_waitcnt lgkmcnt(6)
    v_mfma_f32_16x16x32_bf16 v[0:3], v[84:87], v[104:107], v[0:3]
    ds_read_b64_tr_b16 v[76:77], v180 offset:24576
    v_mfma_f32_16x16x32_bf16 v[4:7], v[84:87], v[108:111], v[4:7]
    ds_read_b64_tr_b16 v[78:79], v180 offset:26624
    s_add_u32 m0, s62, 106496
    s_and_b32 s40, s33, 1
    s_mul_i32 s40, s40, 36864
    s_add_u32 s40, s40, s55
    s_add_u32 s40, s40, 147456
    buffer_load_dwordx4 v234, s[12:15], s40 offen lds
    s_waitcnt lgkmcnt(6)
    v_mfma_f32_16x16x32_bf16 v[8:11], v[88:91], v[104:107], v[8:11]
    ds_read_b64_tr_b16 v[80:81], v181 offset:24576
    v_mfma_f32_16x16x32_bf16 v[12:15], v[88:91], v[108:111], v[12:15]
    ds_read_b64_tr_b16 v[82:83], v181 offset:26624
    s_waitcnt lgkmcnt(6)
    v_mfma_f32_16x16x32_bf16 v[16:19], v[92:95], v[104:107], v[16:19]
    ds_read_b64_tr_b16 v[84:85], v182 offset:24576
    v_mfma_f32_16x16x32_bf16 v[20:23], v[92:95], v[108:111], v[20:23]
    ds_read_b64_tr_b16 v[86:87], v182 offset:26624
    s_waitcnt lgkmcnt(6)
    v_mfma_f32_16x16x32_bf16 v[24:27], v[72:75], v[104:107], v[24:27]
    ds_read_b64_tr_b16 v[88:89], v183 offset:24576
    v_mfma_f32_16x16x32_bf16 v[28:31], v[72:75], v[108:111], v[28:31]
    ds_read_b64_tr_b16 v[90:91], v183 offset:26624
    s_waitcnt lgkmcnt(6)
    v_mfma_f32_16x16x32_bf16 v[32:35], v[76:79], v[104:107], v[32:35]
    ds_read_b64_tr_b16 v[92:93], v192 offset:3072
    v_mfma_f32_16x16x32_bf16 v[36:39], v[76:79], v[108:111], v[36:39]
    ds_read_b64_tr_b16 v[94:95], v192 offset:3328
    s_waitcnt lgkmcnt(6)
    v_mfma_f32_16x16x32_bf16 v[40:43], v[80:83], v[104:107], v[40:43]
    ds_read_b64_tr_b16 v[72:73], v176 offset:0
    v_mfma_f32_16x16x32_bf16 v[44:47], v[80:83], v[108:111], v[44:47]
    ds_read_b64_tr_b16 v[74:75], v176 offset:2048
    s_waitcnt lgkmcnt(6)
    v_mfma_f32_16x16x32_bf16 v[48:51], v[84:87], v[104:107], v[48:51]
    ds_read_b64_tr_b16 v[76:77], v177 offset:0
    v_mfma_f32_16x16x32_bf16 v[52:55], v[84:87], v[108:111], v[52:55]
    ds_read_b64_tr_b16 v[78:79], v177 offset:2048
    s_waitcnt lgkmcnt(6)
    v_mfma_f32_16x16x32_bf16 v[56:59], v[88:91], v[104:107], v[56:59]
    ds_read_b64_tr_b16 v[80:81], v178 offset:0
    v_mfma_f32_16x16x32_bf16 v[60:63], v[88:91], v[108:111], v[60:63]
    ds_read_b64_tr_b16 v[82:83], v178 offset:2048
    s_waitcnt lgkmcnt(6)
    v_mfma_f32_16x16x32_bf16 v[64:67], v[92:95], v[104:107], v[64:67]
    ds_read_b64_tr_b16 v[84:85], v179 offset:0
    v_mfma_f32_16x16x32_bf16 v[68:71], v[92:95], v[108:111], v[68:71]
    ds_read_b64_tr_b16 v[86:87], v179 offset:2048
    s_waitcnt lgkmcnt(6)
    v_mfma_f32_16x16x32_bf16 v[0:3], v[72:75], v[128:131], v[0:3]
    ds_read_b64_tr_b16 v[88:89], v180 offset:0
    v_mfma_f32_16x16x32_bf16 v[4:7], v[72:75], v[132:135], v[4:7]
    ds_read_b64_tr_b16 v[90:91], v180 offset:2048
    s_waitcnt lgkmcnt(6)
    v_mfma_f32_16x16x32_bf16 v[8:11], v[76:79], v[128:131], v[8:11]
    ds_read_b64_tr_b16 v[92:93], v181 offset:0
    v_mfma_f32_16x16x32_bf16 v[12:15], v[76:79], v[132:135], v[12:15]
    ds_read_b64_tr_b16 v[94:95], v181 offset:2048
    s_waitcnt lgkmcnt(6)
    v_mfma_f32_16x16x32_bf16 v[16:19], v[80:83], v[128:131], v[16:19]
    ds_read_b64_tr_b16 v[72:73], v182 offset:0
    v_mfma_f32_16x16x32_bf16 v[20:23], v[80:83], v[132:135], v[20:23]
    ds_read_b64_tr_b16 v[74:75], v182 offset:2048
    s_waitcnt lgkmcnt(6)
    v_mfma_f32_16x16x32_bf16 v[24:27], v[84:87], v[128:131], v[24:27]
    ds_read_b64_tr_b16 v[76:77], v183 offset:0
    v_mfma_f32_16x16x32_bf16 v[28:31], v[84:87], v[132:135], v[28:31]
    ds_read_b64_tr_b16 v[78:79], v183 offset:2048
    s_waitcnt lgkmcnt(6)
    v_mfma_f32_16x16x32_bf16 v[32:35], v[88:91], v[128:131], v[32:35]
    ds_read_b64_tr_b16 v[80:81], v192 offset:0
    v_mfma_f32_16x16x32_bf16 v[36:39], v[88:91], v[132:135], v[36:39]
    ds_read_b64_tr_b16 v[82:83], v192 offset:256
    s_waitcnt lgkmcnt(6)
    v_mfma_f32_16x16x32_bf16 v[40:43], v[92:95], v[128:131], v[40:43]
    ds_read_b64_tr_b16 v[84:85], v176 offset:8192
    v_mfma_f32_16x16x32_bf16 v[44:47], v[92:95], v[132:135], v[44:47]
    ds_read_b64_tr_b16 v[86:87], v176 offset:10240
    s_waitcnt lgkmcnt(6)
    v_mfma_f32_16x16x32_bf16 v[48:51], v[72:75], v[128:131], v[48:51]
    ds_read_b64_tr_b16 v[88:89], v177 offset:8192
    v_mfma_f32_16x16x32_bf16 v[52:55], v[72:75], v[132:135], v[52:55]
    ds_read_b64_tr_b16 v[90:91], v177 offset:10240
    s_waitcnt lgkmcnt(6)
    v_mfma_f32_16x16x32_bf16 v[56:59], v[76:79], v[128:131], v[56:59]
    ds_read_b64_tr_b16 v[92:93], v178 offset:8192
    v_mfma_f32_16x16x32_bf16 v[60:63], v[76:79], v[132:135], v[60:63]
    ds_read_b64_tr_b16 v[94:95], v178 offset:10240
    s_waitcnt lgkmcnt(6)
    v_mfma_f32_16x16x32_bf16 v[64:67], v[80:83], v[128:131], v[64:67]
    ds_read_b64_tr_b16 v[72:73], v179 offset:8192
    v_mfma_f32_16x16x32_bf16 v[68:71], v[80:83], v[132:135], v[68:71]
    ds_read_b64_tr_b16 v[74:75], v179 offset:10240
    s_waitcnt lgkmcnt(6)
    v_mfma_f32_16x16x32_bf16 v[0:3], v[84:87], v[136:139], v[0:3]
    ds_read_b64_tr_b16 v[76:77], v180 offset:8192
    v_mfma_f32_16x16x32_bf16 v[4:7], v[84:87], v[140:143], v[4:7]
    ds_read_b64_tr_b16 v[78:79], v180 offset:10240
    s_waitcnt lgkmcnt(6)
    v_mfma_f32_16x16x32_bf16 v[8:11], v[88:91], v[136:139], v[8:11]
    ds_read_b64_tr_b16 v[80:81], v181 offset:8192
    v_mfma_f32_16x16x32_bf16 v[12:15], v[88:91], v[140:143], v[12:15]
    ds_read_b64_tr_b16 v[82:83], v181 offset:10240
    s_waitcnt lgkmcnt(6)
    v_mfma_f32_16x16x32_bf16 v[16:19], v[92:95], v[136:139], v[16:19]
    ds_read_b64_tr_b16 v[84:85], v182 offset:8192
    v_mfma_f32_16x16x32_bf16 v[20:23], v[92:95], v[140:143], v[20:23]
    ds_read_b64_tr_b16 v[86:87], v182 offset:10240
    s_waitcnt lgkmcnt(6)
    v_mfma_f32_16x16x32_bf16 v[24:27], v[72:75], v[136:139], v[24:27]
    ds_read_b64_tr_b16 v[88:89], v183 offset:8192
    v_mfma_f32_16x16x32_bf16 v[28:31], v[72:75], v[140:143], v[28:31]
    ds_read_b64_tr_b16 v[90:91], v183 offset:10240
    s_waitcnt lgkmcnt(6)
    v_mfma_f32_16x16x32_bf16 v[32:35], v[76:79], v[136:139], v[32:35]
    ds_read_b64_tr_b16 v[92:93], v192 offset:1024
    v_mfma_f32_16x16x32_bf16 v[36:39], v[76:79], v[140:143], v[36:39]
    ds_read_b64_tr_b16 v[94:95], v192 offset:1280
    s_barrier
    s_waitcnt lgkmcnt(6)
    v_mfma_f32_16x16x32_bf16 v[40:43], v[80:83], v[136:139], v[40:43]
    ds_read_b64_tr_b16 v[72:73], v176 offset:36864
    v_mfma_f32_16x16x32_bf16 v[44:47], v[80:83], v[140:143], v[44:47]
    ds_read_b64_tr_b16 v[74:75], v176 offset:38912
    s_waitcnt lgkmcnt(6)
    v_mfma_f32_16x16x32_bf16 v[48:51], v[84:87], v[136:139], v[48:51]
    ds_read_b64_tr_b16 v[76:77], v177 offset:36864
    v_mfma_f32_16x16x32_bf16 v[52:55], v[84:87], v[140:143], v[52:55]
    ds_read_b64_tr_b16 v[78:79], v177 offset:38912
    s_waitcnt lgkmcnt(6)
    v_mfma_f32_16x16x32_bf16 v[56:59], v[88:91], v[136:139], v[56:59]
    ds_read_b64_tr_b16 v[80:81], v178 offset:36864
    v_mfma_f32_16x16x32_bf16 v[60:63], v[88:91], v[140:143], v[60:63]
    ds_read_b64_tr_b16 v[82:83], v178 offset:38912
    s_waitcnt lgkmcnt(6)
    v_mfma_f32_16x16x32_bf16 v[64:67], v[92:95], v[136:139], v[64:67]
    ds_read_b64_tr_b16 v[84:85], v179 offset:36864
    v_mfma_f32_16x16x32_bf16 v[68:71], v[92:95], v[140:143], v[68:71]
    ds_read_b64_tr_b16 v[86:87], v179 offset:38912
    s_waitcnt lgkmcnt(6)
    v_mfma_f32_16x16x32_bf16 v[0:3], v[72:75], v[144:147], v[0:3]
    ds_read_b64_tr_b16 v[88:89], v180 offset:36864
    v_mfma_f32_16x16x32_bf16 v[4:7], v[72:75], v[148:151], v[4:7]
    ds_read_b64_tr_b16 v[90:91], v180 offset:38912
    s_waitcnt lgkmcnt(6)
    v_mfma_f32_16x16x32_bf16 v[8:11], v[76:79], v[144:147], v[8:11]
    ds_read_b64_tr_b16 v[92:93], v181 offset:36864
    v_mfma_f32_16x16x32_bf16 v[12:15], v[76:79], v[148:151], v[12:15]
    ds_read_b64_tr_b16 v[94:95], v181 offset:38912
    s_add_u32 s39, s53, 10240
    buffer_load_dwordx4 v[128:131], v165, s[20:23], s39 offen offset:0 sc1
    s_waitcnt lgkmcnt(6)
    v_mfma_f32_16x16x32_bf16 v[16:19], v[80:83], v[144:147], v[16:19]
    ds_read_b64_tr_b16 v[72:73], v182 offset:36864
    v_mfma_f32_16x16x32_bf16 v[20:23], v[80:83], v[148:151], v[20:23]
    ds_read_b64_tr_b16 v[74:75], v182 offset:38912
    buffer_load_dwordx4 v[132:135], v165, s[20:23], s39 offen offset:1024 sc1
    s_waitcnt lgkmcnt(6)
    v_mfma_f32_16x16x32_bf16 v[24:27], v[84:87], v[144:147], v[24:27]
    ds_read_b64_tr_b16 v[76:77], v183 offset:36864
    v_mfma_f32_16x16x32_bf16 v[28:31], v[84:87], v[148:151], v[28:31]
    ds_read_b64_tr_b16 v[78:79], v183 offset:38912
    s_add_u32 s39, s95, 10240
    buffer_load_dwordx4 v[136:139], v165, s[20:23], s39 offen offset:0 sc1
    s_waitcnt lgkmcnt(6)
    v_mfma_f32_16x16x32_bf16 v[32:35], v[88:91], v[144:147], v[32:35]
    ds_read_b64_tr_b16 v[80:81], v192 offset:36864
    v_mfma_f32_16x16x32_bf16 v[36:39], v[88:91], v[148:151], v[36:39]
    ds_read_b64_tr_b16 v[82:83], v192 offset:37120
    buffer_load_dwordx4 v[140:143], v165, s[20:23], s39 offen offset:1024 sc1
    s_waitcnt lgkmcnt(6)
    v_mfma_f32_16x16x32_bf16 v[40:43], v[92:95], v[144:147], v[40:43]
    ds_read_b64_tr_b16 v[84:85], v176 offset:45056
    v_mfma_f32_16x16x32_bf16 v[44:47], v[92:95], v[148:151], v[44:47]
    ds_read_b64_tr_b16 v[86:87], v176 offset:47104
    s_add_u32 m0, s62, 110592
    s_add_u32 s40, s54, 184320
    buffer_load_dwordx4 v232, s[12:15], s40 offen lds
    s_waitcnt lgkmcnt(6)
    v_mfma_f32_16x16x32_bf16 v[48:51], v[72:75], v[144:147], v[48:51]
    ds_read_b64_tr_b16 v[88:89], v177 offset:45056
    v_mfma_f32_16x16x32_bf16 v[52:55], v[72:75], v[148:151], v[52:55]
    ds_read_b64_tr_b16 v[90:91], v177 offset:47104
    s_add_u32 m0, s62, 118784
    s_add_u32 s40, s54, 552960
    buffer_load_dwordx4 v232, s[12:15], s40 offen lds
    s_waitcnt lgkmcnt(6)
    v_mfma_f32_16x16x32_bf16 v[56:59], v[76:79], v[144:147], v[56:59]
    ds_read_b64_tr_b16 v[92:93], v178 offset:45056
    v_mfma_f32_16x16x32_bf16 v[60:63], v[76:79], v[148:151], v[60:63]
    ds_read_b64_tr_b16 v[94:95], v178 offset:47104
    s_add_u32 m0, s62, 126976
    s_add_u32 s40, s54, 847872
    buffer_load_dwordx4 v232, s[12:15], s40 offen lds
    s_waitcnt lgkmcnt(6)
    v_mfma_f32_16x16x32_bf16 v[64:67], v[80:83], v[144:147], v[64:67]
    ds_read_b64_tr_b16 v[72:73], v179 offset:45056
    v_mfma_f32_16x16x32_bf16 v[68:71], v[80:83], v[148:151], v[68:71]
    ds_read_b64_tr_b16 v[74:75], v179 offset:47104
    s_add_u32 m0, s62, 135168
    s_add_u32 s40, s54, 1216512
    buffer_load_dwordx4 v232, s[12:15], s40 offen lds
    s_waitcnt lgkmcnt(6)
    v_mfma_f32_16x16x32_bf16 v[0:3], v[84:87], v[152:155], v[0:3]
    ds_read_b64_tr_b16 v[76:77], v180 offset:45056
    v_mfma_f32_16x16x32_bf16 v[4:7], v[84:87], v[156:159], v[4:7]
    ds_read_b64_tr_b16 v[78:79], v180 offset:47104
    s_add_u32 m0, s62, 143360
    s_and_b32 s40, s33, 1
    s_mul_i32 s40, s40, 36864
    s_add_u32 s40, s40, s55
    s_add_u32 s40, s40, 184320
    buffer_load_dwordx4 v234, s[12:15], s40 offen lds
    s_waitcnt lgkmcnt(6)
    v_mfma_f32_16x16x32_bf16 v[8:11], v[88:91], v[152:155], v[8:11]
    ds_read_b64_tr_b16 v[80:81], v181 offset:45056
    v_mfma_f32_16x16x32_bf16 v[12:15], v[88:91], v[156:159], v[12:15]
    ds_read_b64_tr_b16 v[82:83], v181 offset:47104
    s_waitcnt lgkmcnt(6)
    v_mfma_f32_16x16x32_bf16 v[16:19], v[92:95], v[152:155], v[16:19]
    ds_read_b64_tr_b16 v[84:85], v182 offset:45056
    v_mfma_f32_16x16x32_bf16 v[20:23], v[92:95], v[156:159], v[20:23]
    ds_read_b64_tr_b16 v[86:87], v182 offset:47104
    s_waitcnt lgkmcnt(6)
    v_mfma_f32_16x16x32_bf16 v[24:27], v[72:75], v[152:155], v[24:27]
    ds_read_b64_tr_b16 v[88:89], v183 offset:45056
    v_mfma_f32_16x16x32_bf16 v[28:31], v[72:75], v[156:159], v[28:31]
    ds_read_b64_tr_b16 v[90:91], v183 offset:47104
    s_waitcnt lgkmcnt(6)
    v_mfma_f32_16x16x32_bf16 v[32:35], v[76:79], v[152:155], v[32:35]
    ds_read_b64_tr_b16 v[92:93], v192 offset:37888
    v_mfma_f32_16x16x32_bf16 v[36:39], v[76:79], v[156:159], v[36:39]
    ds_read_b64_tr_b16 v[94:95], v192 offset:38144
    s_waitcnt vmcnt(9)
    s_barrier
    s_waitcnt lgkmcnt(6)
    v_mfma_f32_16x16x32_bf16 v[40:43], v[80:83], v[152:155], v[40:43]
    ds_read_b64_tr_b16 v[72:73], v184 offset:0
    v_mfma_f32_16x16x32_bf16 v[44:47], v[80:83], v[156:159], v[44:47]
    ds_read_b64_tr_b16 v[74:75], v184 offset:2048
    s_waitcnt lgkmcnt(6)
    v_mfma_f32_16x16x32_bf16 v[48:51], v[84:87], v[152:155], v[48:51]
    ds_read_b64_tr_b16 v[76:77], v185 offset:0
    v_mfma_f32_16x16x32_bf16 v[52:55], v[84:87], v[156:159], v[52:55]
    ds_read_b64_tr_b16 v[78:79], v185 offset:2048
    s_waitcnt lgkmcnt(6)
    v_mfma_f32_16x16x32_bf16 v[56:59], v[88:91], v[152:155], v[56:59]
    ds_read_b64_tr_b16 v[80:81], v186 offset:0
    v_mfma_f32_16x16x32_bf16 v[60:63], v[88:91], v[156:159], v[60:63]
    ds_read_b64_tr_b16 v[82:83], v186 offset:2048
    s_waitcnt lgkmcnt(6)
    v_mfma_f32_16x16x32_bf16 v[64:67], v[92:95], v[152:155], v[64:67]
    ds_read_b64_tr_b16 v[84:85], v187 offset:0
    v_mfma_f32_16x16x32_bf16 v[68:71], v[92:95], v[156:159], v[68:71]
    ds_read_b64_tr_b16 v[86:87], v187 offset:2048
    s_waitcnt lgkmcnt(6)
    v_mfma_f32_16x16x32_bf16 v[0:3], v[72:75], v[112:115], v[0:3]
    ds_read_b64_tr_b16 v[88:89], v188 offset:0
    v_mfma_f32_16x16x32_bf16 v[4:7], v[72:75], v[116:119], v[4:7]
    ds_read_b64_tr_b16 v[90:91], v188 offset:2048
    s_waitcnt lgkmcnt(6)
    v_mfma_f32_16x16x32_bf16 v[8:11], v[76:79], v[112:115], v[8:11]
    ds_read_b64_tr_b16 v[92:93], v189 offset:0
    v_mfma_f32_16x16x32_bf16 v[12:15], v[76:79], v[116:119], v[12:15]
    ds_read_b64_tr_b16 v[94:95], v189 offset:2048
    s_waitcnt lgkmcnt(6)
    v_mfma_f32_16x16x32_bf16 v[16:19], v[80:83], v[112:115], v[16:19]
    ds_read_b64_tr_b16 v[72:73], v190 offset:0
    v_mfma_f32_16x16x32_bf16 v[20:23], v[80:83], v[116:119], v[20:23]
    ds_read_b64_tr_b16 v[74:75], v190 offset:2048
    s_waitcnt lgkmcnt(6)
    v_mfma_f32_16x16x32_bf16 v[24:27], v[84:87], v[112:115], v[24:27]
    ds_read_b64_tr_b16 v[76:77], v191 offset:0
    v_mfma_f32_16x16x32_bf16 v[28:31], v[84:87], v[116:119], v[28:31]
    ds_read_b64_tr_b16 v[78:79], v191 offset:2048
    s_waitcnt lgkmcnt(6)
    v_mfma_f32_16x16x32_bf16 v[32:35], v[88:91], v[112:115], v[32:35]
    ds_read_b64_tr_b16 v[80:81], v193 offset:0
    v_mfma_f32_16x16x32_bf16 v[36:39], v[88:91], v[116:119], v[36:39]
    ds_read_b64_tr_b16 v[82:83], v193 offset:256
    s_waitcnt lgkmcnt(6)
    v_mfma_f32_16x16x32_bf16 v[40:43], v[92:95], v[112:115], v[40:43]
    ds_read_b64_tr_b16 v[84:85], v184 offset:8192
    v_mfma_f32_16x16x32_bf16 v[44:47], v[92:95], v[116:119], v[44:47]
    ds_read_b64_tr_b16 v[86:87], v184 offset:10240
    s_add_u32 m0, s62, 0
    s_add_u32 s40, s54, 221184
    buffer_load_dwordx4 v232, s[12:15], s40 offen lds
    s_waitcnt lgkmcnt(6)
    v_mfma_f32_16x16x32_bf16 v[48:51], v[72:75], v[112:115], v[48:51]
    ds_read_b64_tr_b16 v[88:89], v185 offset:8192
    v_mfma_f32_16x16x32_bf16 v[52:55], v[72:75], v[116:119], v[52:55]
    ds_read_b64_tr_b16 v[90:91], v185 offset:10240
    s_add_u32 m0, s62, 8192
    s_add_u32 s40, s54, 589824
    buffer_load_dwordx4 v232, s[12:15], s40 offen lds
    s_waitcnt lgkmcnt(6)
    v_mfma_f32_16x16x32_bf16 v[56:59], v[76:79], v[112:115], v[56:59]
    ds_read_b64_tr_b16 v[92:93], v186 offset:8192
    v_mfma_f32_16x16x32_bf16 v[60:63], v[76:79], v[116:119], v[60:63]
    ds_read_b64_tr_b16 v[94:95], v186 offset:10240
    s_add_u32 m0, s62, 16384
    s_add_u32 s40, s54, 884736
    buffer_load_dwordx4 v232, s[12:15], s40 offen lds
    s_waitcnt lgkmcnt(6)
    v_mfma_f32_16x16x32_bf16 v[64:67], v[80:83], v[112:115], v[64:67]
    ds_read_b64_tr_b16 v[72:73], v187 offset:8192
    v_mfma_f32_16x16x32_bf16 v[68:71], v[80:83], v[116:119], v[68:71]
    ds_read_b64_tr_b16 v[74:75], v187 offset:10240
    s_add_u32 m0, s62, 24576
    s_add_u32 s40, s54, 1253376
    buffer_load_dwordx4 v232, s[12:15], s40 offen lds
    s_waitcnt lgkmcnt(6)
    v_mfma_f32_16x16x32_bf16 v[0:3], v[84:87], v[120:123], v[0:3]
    ds_read_b64_tr_b16 v[76:77], v188 offset:8192
    v_mfma_f32_16x16x32_bf16 v[4:7], v[84:87], v[124:127], v[4:7]
    ds_read_b64_tr_b16 v[78:79], v188 offset:10240
    s_add_u32 m0, s62, 32768
    s_and_b32 s40, s33, 1
    s_mul_i32 s40, s40, 36864
    s_add_u32 s40, s40, s55
    s_add_u32 s40, s40, 221184
    buffer_load_dwordx4 v234, s[12:15], s40 offen lds
    s_waitcnt lgkmcnt(6)
    v_mfma_f32_16x16x32_bf16 v[8:11], v[88:91], v[120:123], v[8:11]
    ds_read_b64_tr_b16 v[80:81], v189 offset:8192
    v_mfma_f32_16x16x32_bf16 v[12:15], v[88:91], v[124:127], v[12:15]
    ds_read_b64_tr_b16 v[82:83], v189 offset:10240
    buffer_load_dword v163, v164, s[20:23], s60 offen sc1
    s_waitcnt lgkmcnt(6)
    v_mfma_f32_16x16x32_bf16 v[16:19], v[92:95], v[120:123], v[16:19]
    ds_read_b64_tr_b16 v[84:85], v190 offset:8192
    v_mfma_f32_16x16x32_bf16 v[20:23], v[92:95], v[124:127], v[20:23]
    ds_read_b64_tr_b16 v[86:87], v190 offset:10240
    s_waitcnt lgkmcnt(6)
    v_mfma_f32_16x16x32_bf16 v[24:27], v[72:75], v[120:123], v[24:27]
    ds_read_b64_tr_b16 v[88:89], v191 offset:8192
    v_mfma_f32_16x16x32_bf16 v[28:31], v[72:75], v[124:127], v[28:31]
    ds_read_b64_tr_b16 v[90:91], v191 offset:10240
    s_waitcnt lgkmcnt(6)
    v_mfma_f32_16x16x32_bf16 v[32:35], v[76:79], v[120:123], v[32:35]
    ds_read_b64_tr_b16 v[92:93], v193 offset:1024
    v_mfma_f32_16x16x32_bf16 v[36:39], v[76:79], v[124:127], v[36:39]
    ds_read_b64_tr_b16 v[94:95], v193 offset:1280
    s_waitcnt vmcnt(6)
    s_barrier
    s_waitcnt lgkmcnt(6)
    v_mfma_f32_16x16x32_bf16 v[40:43], v[80:83], v[120:123], v[40:43]
    ds_read_b64_tr_b16 v[72:73], v184 offset:36864
    v_mfma_f32_16x16x32_bf16 v[44:47], v[80:83], v[124:127], v[44:47]
    ds_read_b64_tr_b16 v[74:75], v184 offset:38912
    s_waitcnt lgkmcnt(6)
    v_mfma_f32_16x16x32_bf16 v[48:51], v[84:87], v[120:123], v[48:51]
    ds_read_b64_tr_b16 v[76:77], v185 offset:36864
    v_mfma_f32_16x16x32_bf16 v[52:55], v[84:87], v[124:127], v[52:55]
    ds_read_b64_tr_b16 v[78:79], v185 offset:38912
    s_waitcnt lgkmcnt(6)
    v_mfma_f32_16x16x32_bf16 v[56:59], v[88:91], v[120:123], v[56:59]
    ds_read_b64_tr_b16 v[80:81], v186 offset:36864
    v_mfma_f32_16x16x32_bf16 v[60:63], v[88:91], v[124:127], v[60:63]
    ds_read_b64_tr_b16 v[82:83], v186 offset:38912
    s_waitcnt lgkmcnt(6)
    v_mfma_f32_16x16x32_bf16 v[64:67], v[92:95], v[120:123], v[64:67]
    ds_read_b64_tr_b16 v[84:85], v187 offset:36864
    v_mfma_f32_16x16x32_bf16 v[68:71], v[92:95], v[124:127], v[68:71]
    ds_read_b64_tr_b16 v[86:87], v187 offset:38912
    s_waitcnt lgkmcnt(6)
    v_mfma_f32_16x16x32_bf16 v[0:3], v[72:75], v[128:131], v[0:3]
    ds_read_b64_tr_b16 v[88:89], v188 offset:36864
    v_mfma_f32_16x16x32_bf16 v[4:7], v[72:75], v[132:135], v[4:7]
    ds_read_b64_tr_b16 v[90:91], v188 offset:38912
    s_waitcnt vmcnt(0)
    v_cmp_ne_u32 vcc, s35, v163
    s_and_b32 s38, vcc_lo, 0xff000000
    s_and_b32 s39, vcc_hi, 0xf
    s_or_b32 s38, s38, s39
    s_cbranch_scc0 L_ok_6
    s_mov_b32 s61, 0
L_spin_6:
    buffer_load_dword v163, v164, s[20:23], s60 offen sc1
    s_add_u32 s61, s61, 1
    s_cmp_gt_u32 s61, 200000
    s_cbranch_scc1 L_ok_6
    s_waitcnt vmcnt(0)
    v_cmp_ne_u32 vcc, s35, v163
    s_and_b32 s38, vcc_lo, 0xff000000
    s_and_b32 s39, vcc_hi, 0xf
    s_or_b32 s38, s38, s39
    s_cbranch_scc1 L_spin_6
L_ok_6:
    s_waitcnt lgkmcnt(6)
    v_mfma_f32_16x16x32_bf16 v[8:11], v[76:79], v[128:131], v[8:11]
    ds_read_b64_tr_b16 v[92:93], v189 offset:36864
    v_mfma_f32_16x16x32_bf16 v[12:15], v[76:79], v[132:135], v[12:15]
    ds_read_b64_tr_b16 v[94:95], v189 offset:38912
    s_add_u32 s39, s53, 12288
    buffer_load_dwordx4 v[96:99], v165, s[20:23], s39 offen offset:0 sc1
    s_waitcnt lgkmcnt(6)
    v_mfma_f32_16x16x32_bf16 v[16:19], v[80:83], v[128:131], v[16:19]
    ds_read_b64_tr_b16 v[72:73], v190 offset:36864
    v_mfma_f32_16x16x32_bf16 v[20:23], v[80:83], v[132:135], v[20:23]
    ds_read_b64_tr_b16 v[74:75], v190 offset:38912
    buffer_load_dwordx4 v[100:103], v165, s[20:23], s39 offen offset:1024 sc1
    s_waitcnt lgkmcnt(6)
    v_mfma_f32_16x16x32_bf16 v[24:27], v[84:87], v[128:131], v[24:27]
    ds_read_b64_tr_b16 v[76:77], v191 offset:36864
    v_mfma_f32_16x16x32_bf16 v[28:31], v[84:87], v[132:135], v[28:31]
    ds_read_b64_tr_b16 v[78:79], v191 offset:38912
    s_add_u32 s39, s95, 12288
    buffer_load_dwordx4 v[104:107], v165, s[20:23], s39 offen offset:0 sc1
    s_waitcnt lgkmcnt(6)
    v_mfma_f32_16x16x32_bf16 v[32:35], v[88:91], v[128:131], v[32:35]
    ds_read_b64_tr_b16 v[80:81], v193 offset:36864
    v_mfma_f32_16x16x32_bf16 v[36:39], v[88:91], v[132:135], v[36:39]
    ds_read_b64_tr_b16 v[82:83], v193 offset:37120
    buffer_load_dwordx4 v[108:111], v165, s[20:23], s39 offen offset:1024 sc1
    s_waitcnt lgkmcnt(6)
    v_mfma_f32_16x16x32_bf16 v[40:43], v[92:95], v[128:131], v[40:43]
    ds_read_b64_tr_b16 v[84:85], v184 offset:45056
    v_mfma_f32_16x16x32_bf16 v[44:47], v[92:95], v[132:135], v[44:47]
    ds_read_b64_tr_b16 v[86:87], v184 offset:47104
    s_add_u32 m0, s62, 36864
    s_add_u32 s40, s54, 258048
    buffer_load_dwordx4 v232, s[12:15], s40 offen lds
    s_waitcnt lgkmcnt(6)
    v_mfma_f32_16x16x32_bf16 v[48:51], v[72:75], v[128:131], v[48:51]
    ds_read_b64_tr_b16 v[88:89], v185 offset:45056
    v_mfma_f32_16x16x32_bf16 v[52:55], v[72:75], v[132:135], v[52:55]
    ds_read_b64_tr_b16 v[90:91], v185 offset:47104
    s_add_u32 m0, s62, 45056
    s_add_u32 s40, s54, 626688
    buffer_load_dwordx4 v232, s[12:15], s40 offen lds
    s_waitcnt lgkmcnt(6)
    v_mfma_f32_16x16x32_bf16 v[56:59], v[76:79], v[128:131], v[56:59]
    ds_read_b64_tr_b16 v[92:93], v186 offset:45056
    v_mfma_f32_16x16x32_bf16 v[60:63], v[76:79], v[132:135], v[60:63]
    ds_read_b64_tr_b16 v[94:95], v186 offset:47104
    s_add_u32 m0, s62, 53248
    s_add_u32 s40, s54, 921600
    buffer_load_dwordx4 v232, s[12:15], s40 offen lds
    s_waitcnt lgkmcnt(6)
    v_mfma_f32_16x16x32_bf16 v[64:67], v[80:83], v[128:131], v[64:67]
    ds_read_b64_tr_b16 v[72:73], v187 offset:45056
    v_mfma_f32_16x16x32_bf16 v[68:71], v[80:83], v[132:135], v[68:71]
    ds_read_b64_tr_b16 v[74:75], v187 offset:47104
    s_add_u32 m0, s62, 61440
    s_add_u32 s40, s54, 1290240
    buffer_load_dwordx4 v232, s[12:15], s40 offen lds
    s_waitcnt lgkmcnt(6)
    v_mfma_f32_16x16x32_bf16 v[0:3], v[84:87], v[136:139], v[0:3]
    ds_read_b64_tr_b16 v[76:77], v188 offset:45056
    v_mfma_f32_16x16x32_bf16 v[4:7], v[84:87], v[140:143], v[4:7]
    ds_read_b64_tr_b16 v[78:79], v188 offset:47104
    s_add_u32 m0, s62, 69632
    s_and_b32 s40, s33, 1
    s_mul_i32 s40, s40, 36864
    s_add_u32 s40, s40, s55
    s_add_u32 s40, s40, 258048
    buffer_load_dwordx4 v234, s[12:15], s40 offen lds
    s_waitcnt lgkmcnt(6)
    v_mfma_f32_16x16x32_bf16 v[8:11], v[88:91], v[136:139], v[8:11]
    ds_read_b64_tr_b16 v[80:81], v189 offset:45056
    v_mfma_f32_16x16x32_bf16 v[12:15], v[88:91], v[140:143], v[12:15]
    ds_read_b64_tr_b16 v[82:83], v189 offset:47104
    s_add_u32 s39, s53, 14336
    buffer_load_dwordx4 v[112:115], v165, s[20:23], s39 offen offset:0 sc1
    s_waitcnt lgkmcnt(6)
    v_mfma_f32_16x16x32_bf16 v[16:19], v[92:95], v[136:139], v[16:19]
    ds_read_b64_tr_b16 v[84:85], v190 offset:45056
    v_mfma_f32_16x16x32_bf16 v[20:23], v[92:95], v[140:143], v[20:23]
    ds_read_b64_tr_b16 v[86:87], v190 offset:47104
    buffer_load_dwordx4 v[116:119], v165, s[20:23], s39 offen offset:1024 sc1
    s_waitcnt lgkmcnt(6)
    v_mfma_f32_16x16x32_bf16 v[24:27], v[72:75], v[136:139], v[24:27]
    ds_read_b64_tr_b16 v[88:89], v191 offset:45056
    v_mfma_f32_16x16x32_bf16 v[28:31], v[72:75], v[140:143], v[28:31]
    ds_read_b64_tr_b16 v[90:91], v191 offset:47104
    s_add_u32 s39, s95, 14336
    buffer_load_dwordx4 v[120:123], v165, s[20:23], s39 offen offset:0 sc1
    s_waitcnt lgkmcnt(6)
    v_mfma_f32_16x16x32_bf16 v[32:35], v[76:79], v[136:139], v[32:35]
    ds_read_b64_tr_b16 v[92:93], v193 offset:37888
    v_mfma_f32_16x16x32_bf16 v[36:39], v[76:79], v[140:143], v[36:39]
    ds_read_b64_tr_b16 v[94:95], v193 offset:38144
    buffer_load_dwordx4 v[124:127], v165, s[20:23], s39 offen offset:1024 sc1
    s_barrier
    s_waitcnt lgkmcnt(6)
    v_mfma_f32_16x16x32_bf16 v[40:43], v[80:83], v[136:139], v[40:43]
    ds_read_b64_tr_b16 v[72:73], v176 offset:0
    v_mfma_f32_16x16x32_bf16 v[44:47], v[80:83], v[140:143], v[44:47]
    ds_read_b64_tr_b16 v[74:75], v176 offset:2048
    s_waitcnt lgkmcnt(6)
    v_mfma_f32_16x16x32_bf16 v[48:51], v[84:87], v[136:139], v[48:51]
    ds_read_b64_tr_b16 v[76:77], v177 offset:0
    v_mfma_f32_16x16x32_bf16 v[52:55], v[84:87], v[140:143], v[52:55]
    ds_read_b64_tr_b16 v[78:79], v177 offset:2048
    s_waitcnt lgkmcnt(6)
    v_mfma_f32_16x16x32_bf16 v[56:59], v[88:91], v[136:139], v[56:59]
    ds_read_b64_tr_b16 v[80:81], v178 offset:0
    v_mfma_f32_16x16x32_bf16 v[60:63], v[88:91], v[140:143], v[60:63]
    ds_read_b64_tr_b16 v[82:83], v178 offset:2048
    s_waitcnt lgkmcnt(6)
    v_mfma_f32_16x16x32_bf16 v[64:67], v[92:95], v[136:139], v[64:67]
    ds_read_b64_tr_b16 v[84:85], v179 offset:0
    v_mfma_f32_16x16x32_bf16 v[68:71], v[92:95], v[140:143], v[68:71]
    ds_read_b64_tr_b16 v[86:87], v179 offset:2048
    s_waitcnt vmcnt(9)
    s_waitcnt lgkmcnt(6)
    v_mfma_f32_16x16x32_bf16 v[0:3], v[72:75], v[96:99], v[0:3]
    ds_read_b64_tr_b16 v[88:89], v180 offset:0
    v_mfma_f32_16x16x32_bf16 v[4:7], v[72:75], v[100:103], v[4:7]
    ds_read_b64_tr_b16 v[90:91], v180 offset:2048
    s_waitcnt lgkmcnt(6)
    v_mfma_f32_16x16x32_bf16 v[8:11], v[76:79], v[96:99], v[8:11]
    ds_read_b64_tr_b16 v[92:93], v181 offset:0
    v_mfma_f32_16x16x32_bf16 v[12:15], v[76:79], v[100:103], v[12:15]
    ds_read_b64_tr_b16 v[94:95], v181 offset:2048
    s_add_u32 s39, s53, 16384
    buffer_load_dwordx4 v[128:131], v165, s[20:23], s39 offen offset:0 sc1
    s_waitcnt lgkmcnt(6)
    v_mfma_f32_16x16x32_bf16 v[16:19], v[80:83], v[96:99], v[16:19]
    ds_read_b64_tr_b16 v[72:73], v182 offset:0
    v_mfma_f32_16x16x32_bf16 v[20:23], v[80:83], v[100:103], v[20:23]
    ds_read_b64_tr_b16 v[74:75], v182 offset:2048
    buffer_load_dwordx4 v[132:135], v165, s[20:23], s39 offen offset:1024 sc1
    s_waitcnt lgkmcnt(6)
    v_mfma_f32_16x16x32_bf16 v[24:27], v[84:87], v[96:99], v[24:27]
    ds_read_b64_tr_b16 v[76:77], v183 offset:0
    v_mfma_f32_16x16x32_bf16 v[28:31], v[84:87], v[100:103], v[28:31]
    ds_read_b64_tr_b16 v[78:79], v183 offset:2048
    s_add_u32 s39, s95, 16384
    buffer_load_dwordx4 v[136:139], v165, s[20:23], s39 offen offset:0 sc1
    s_waitcnt lgkmcnt(6)
    v_mfma_f32_16x16x32_bf16 v[32:35], v[88:91], v[96:99], v[32:35]
    ds_read_b64_tr_b16 v[80:81], v192 offset:0
    v_mfma_f32_16x16x32_bf16 v[36:39], v[88:91], v[100:103], v[36:39]
    ds_read_b64_tr_b16 v[82:83], v192 offset:256
    buffer_load_dwordx4 v[140:143], v165, s[20:23], s39 offen offset:1024 sc1
    s_waitcnt lgkmcnt(6)
    v_mfma_f32_16x16x32_bf16 v[40:43], v[92:95], v[96:99], v[40:43]
    ds_read_b64_tr_b16 v[84:85], v176 offset:8192
    v_mfma_f32_16x16x32_bf16 v[44:47], v[92:95], v[100:103], v[44:47]
    ds_read_b64_tr_b16 v[86:87], v176 offset:10240
    s_add_u32 m0, s62, 73728
    s_add_u32 s40, s54, 294912
    buffer_load_dwordx4 v232, s[12:15], s40 offen lds
    s_waitcnt lgkmcnt(6)
    v_mfma_f32_16x16x32_bf16 v[48:51], v[72:75], v[96:99], v[48:51]
    ds_read_b64_tr_b16 v[88:89], v177 offset:8192
    v_mfma_f32_16x16x32_bf16 v[52:55], v[72:75], v[100:103], v[52:55]
    ds_read_b64_tr_b16 v[90:91], v177 offset:10240
    s_add_u32 m0, s62, 81920
    s_add_u32 s40, s54, 331776
    buffer_load_dwordx4 v232, s[12:15], s40 offen lds
    s_waitcnt lgkmcnt(6)
    v_mfma_f32_16x16x32_bf16 v[56:59], v[76:79], v[96:99], v[56:59]
    ds_read_b64_tr_b16 v[92:93], v178 offset:8192
    v_mfma_f32_16x16x32_bf16 v[60:63], v[76:79], v[100:103], v[60:63]
    ds_read_b64_tr_b16 v[94:95], v178 offset:10240
    s_add_u32 m0, s62, 90112
    s_add_u32 s40, s54, 958464
    buffer_load_dwordx4 v232, s[12:15], s40 offen lds
    s_waitcnt lgkmcnt(6)
    v_mfma_f32_16x16x32_bf16 v[64:67], v[80:83], v[96:99], v[64:67]
    ds_read_b64_tr_b16 v[72:73], v179 offset:8192
    v_mfma_f32_16x16x32_bf16 v[68:71], v[80:83], v[100:103], v[68:71]
    ds_read_b64_tr_b16 v[74:75], v179 offset:10240
    s_add_u32 m0, s62, 98304
    s_add_u32 s40, s54, 995328
    buffer_load_dwordx4 v232, s[12:15], s40 offen lds
    s_waitcnt lgkmcnt(6)
    v_mfma_f32_16x16x32_bf16 v[0:3], v[84:87], v[104:107], v[0:3]
    ds_read_b64_tr_b16 v[76:77], v180 offset:8192
    v_mfma_f32_16x16x32_bf16 v[4:7], v[84:87], v[108:111], v[4:7]
    ds_read_b64_tr_b16 v[78:79], v180 offset:10240
    s_add_u32 m0, s62, 106496
    s_and_b32 s40, s33, 1
    s_mul_i32 s40, s40, -294912
    s_add_u32 s40, s40, s55
    s_add_u32 s40, s40, 294912
    buffer_load_dwordx4 v234, s[12:15], s40 offen lds
    s_waitcnt lgkmcnt(6)
    v_mfma_f32_16x16x32_bf16 v[8:11], v[88:91], v[104:107], v[8:11]
    ds_read_b64_tr_b16 v[80:81], v181 offset:8192
    v_mfma_f32_16x16x32_bf16 v[12:15], v[88:91], v[108:111], v[12:15]
    ds_read_b64_tr_b16 v[82:83], v181 offset:10240
    s_waitcnt lgkmcnt(6)
    v_mfma_f32_16x16x32_bf16 v[16:19], v[92:95], v[104:107], v[16:19]
    ds_read_b64_tr_b16 v[84:85], v182 offset:8192
    v_mfma_f32_16x16x32_bf16 v[20:23], v[92:95], v[108:111], v[20:23]
    ds_read_b64_tr_b16 v[86:87], v182 offset:10240
    s_waitcnt lgkmcnt(6)
    v_mfma_f32_16x16x32_bf16 v[24:27], v[72:75], v[104:107], v[24:27]
    ds_read_b64_tr_b16 v[88:89], v183 offset:8192
    v_mfma_f32_16x16x32_bf16 v[28:31], v[72:75], v[108:111], v[28:31]
    ds_read_b64_tr_b16 v[90:91], v183 offset:10240
    s_waitcnt lgkmcnt(6)
    v_mfma_f32_16x16x32_bf16 v[32:35], v[76:79], v[104:107], v[32:35]
    ds_read_b64_tr_b16 v[92:93], v192 offset:1024
    v_mfma_f32_16x16x32_bf16 v[36:39], v[76:79], v[108:111], v[36:39]
    ds_read_b64_tr_b16 v[94:95], v192 offset:1280
    s_waitcnt vmcnt(13)
    s_barrier
    s_waitcnt lgkmcnt(6)
    v_mfma_f32_16x16x32_bf16 v[40:43], v[80:83], v[104:107], v[40:43]
    ds_read_b64_tr_b16 v[72:73], v176 offset:36864
    v_mfma_f32_16x16x32_bf16 v[44:47], v[80:83], v[108:111], v[44:47]
    ds_read_b64_tr_b16 v[74:75], v176 offset:38912
    s_waitcnt lgkmcnt(6)
    v_mfma_f32_16x16x32_bf16 v[48:51], v[84:87], v[104:107], v[48:51]
    ds_read_b64_tr_b16 v[76:77], v177 offset:36864
    v_mfma_f32_16x16x32_bf16 v[52:55], v[84:87], v[108:111], v[52:55]
    ds_read_b64_tr_b16 v[78:79], v177 offset:38912
    s_waitcnt lgkmcnt(6)
    v_mfma_f32_16x16x32_bf16 v[56:59], v[88:91], v[104:107], v[56:59]
    ds_read_b64_tr_b16 v[80:81], v178 offset:36864
    v_mfma_f32_16x16x32_bf16 v[60:63], v[88:91], v[108:111], v[60:63]
    ds_read_b64_tr_b16 v[82:83], v178 offset:38912
    s_waitcnt lgkmcnt(6)
    v_mfma_f32_16x16x32_bf16 v[64:67], v[92:95], v[104:107], v[64:67]
    ds_read_b64_tr_b16 v[84:85], v179 offset:36864
    v_mfma_f32_16x16x32_bf16 v[68:71], v[92:95], v[108:111], v[68:71]
    ds_read_b64_tr_b16 v[86:87], v179 offset:38912
    s_waitcnt vmcnt(9)
    s_waitcnt lgkmcnt(6)
    v_mfma_f32_16x16x32_bf16 v[0:3], v[72:75], v[112:115], v[0:3]
    ds_read_b64_tr_b16 v[88:89], v180 offset:36864
    v_mfma_f32_16x16x32_bf16 v[4:7], v[72:75], v[116:119], v[4:7]
    ds_read_b64_tr_b16 v[90:91], v180 offset:38912
    s_waitcnt lgkmcnt(6)
    v_mfma_f32_16x16x32_bf16 v[8:11], v[76:79], v[112:115], v[8:11]
    ds_read_b64_tr_b16 v[92:93], v181 offset:36864
    v_mfma_f32_16x16x32_bf16 v[12:15], v[76:79], v[116:119], v[12:15]
    ds_read_b64_tr_b16 v[94:95], v181 offset:38912
    s_waitcnt lgkmcnt(6)
    v_mfma_f32_16x16x32_bf16 v[16:19], v[80:83], v[112:115], v[16:19]
    ds_read_b64_tr_b16 v[72:73], v182 offset:36864
    v_mfma_f32_16x16x32_bf16 v[20:23], v[80:83], v[116:119], v[20:23]
    ds_read_b64_tr_b16 v[74:75], v182 offset:38912
    s_waitcnt lgkmcnt(6)
    v_mfma_f32_16x16x32_bf16 v[24:27], v[84:87], v[112:115], v[24:27]
    ds_read_b64_tr_b16 v[76:77], v183 offset:36864
    v_mfma_f32_16x16x32_bf16 v[28:31], v[84:87], v[116:119], v[28:31]
    ds_read_b64_tr_b16 v[78:79], v183 offset:38912
    s_waitcnt lgkmcnt(6)
    v_mfma_f32_16x16x32_bf16 v[32:35], v[88:91], v[112:115], v[32:35]
    ds_read_b64_tr_b16 v[80:81], v192 offset:36864
    v_mfma_f32_16x16x32_bf16 v[36:39], v[88:91], v[116:119], v[36:39]
    ds_read_b64_tr_b16 v[82:83], v192 offset:37120
    s_waitcnt lgkmcnt(6)
    v_mfma_f32_16x16x32_bf16 v[40:43], v[92:95], v[112:115], v[40:43]
    ds_read_b64_tr_b16 v[84:85], v176 offset:45056
    v_mfma_f32_16x16x32_bf16 v[44:47], v[92:95], v[116:119], v[44:47]
    ds_read_b64_tr_b16 v[86:87], v176 offset:47104
    s_waitcnt lgkmcnt(6)
    v_mfma_f32_16x16x32_bf16 v[48:51], v[72:75], v[112:115], v[48:51]
    ds_read_b64_tr_b16 v[88:89], v177 offset:45056
    v_mfma_f32_16x16x32_bf16 v[52:55], v[72:75], v[116:119], v[52:55]
    ds_read_b64_tr_b16 v[90:91], v177 offset:47104
    s_waitcnt lgkmcnt(6)
    v_mfma_f32_16x16x32_bf16 v[56:59], v[76:79], v[112:115], v[56:59]
    ds_read_b64_tr_b16 v[92:93], v178 offset:45056
    v_mfma_f32_16x16x32_bf16 v[60:63], v[76:79], v[116:119], v[60:63]
    ds_read_b64_tr_b16 v[94:95], v178 offset:47104
    s_waitcnt lgkmcnt(6)
    v_mfma_f32_16x16x32_bf16 v[64:67], v[80:83], v[112:115], v[64:67]
    ds_read_b64_tr_b16 v[72:73], v179 offset:45056
    v_mfma_f32_16x16x32_bf16 v[68:71], v[80:83], v[116:119], v[68:71]
    ds_read_b64_tr_b16 v[74:75], v179 offset:47104
    s_waitcnt lgkmcnt(6)
    v_mfma_f32_16x16x32_bf16 v[0:3], v[84:87], v[120:123], v[0:3]
    ds_read_b64_tr_b16 v[76:77], v180 offset:45056
    v_mfma_f32_16x16x32_bf16 v[4:7], v[84:87], v[124:127], v[4:7]
    ds_read_b64_tr_b16 v[78:79], v180 offset:47104
    s_waitcnt lgkmcnt(6)
    v_mfma_f32_16x16x32_bf16 v[8:11], v[88:91], v[120:123], v[8:11]
    ds_read_b64_tr_b16 v[80:81], v181 offset:45056
    v_mfma_f32_16x16x32_bf16 v[12:15], v[88:91], v[124:127], v[12:15]
    ds_read_b64_tr_b16 v[82:83], v181 offset:47104
    s_waitcnt lgkmcnt(6)
    v_mfma_f32_16x16x32_bf16 v[16:19], v[92:95], v[120:123], v[16:19]
    ds_read_b64_tr_b16 v[84:85], v182 offset:45056
    v_mfma_f32_16x16x32_bf16 v[20:23], v[92:95], v[124:127], v[20:23]
    ds_read_b64_tr_b16 v[86:87], v182 offset:47104
    s_waitcnt lgkmcnt(6)
    v_mfma_f32_16x16x32_bf16 v[24:27], v[72:75], v[120:123], v[24:27]
    ds_read_b64_tr_b16 v[88:89], v183 offset:45056
    v_mfma_f32_16x16x32_bf16 v[28:31], v[72:75], v[124:127], v[28:31]
    ds_read_b64_tr_b16 v[90:91], v183 offset:47104
    s_waitcnt lgkmcnt(6)
    v_mfma_f32_16x16x32_bf16 v[32:35], v[76:79], v[120:123], v[32:35]
    ds_read_b64_tr_b16 v[92:93], v192 offset:37888
    v_mfma_f32_16x16x32_bf16 v[36:39], v[76:79], v[124:127], v[36:39]
    ds_read_b64_tr_b16 v[94:95], v192 offset:38144
    s_waitcnt vmcnt(0)
    s_barrier
    s_waitcnt lgkmcnt(6)
    v_mfma_f32_16x16x32_bf16 v[40:43], v[80:83], v[120:123], v[40:43]
    ds_read_b64_tr_b16 v[72:73], v184 offset:0
    v_mfma_f32_16x16x32_bf16 v[44:47], v[80:83], v[124:127], v[44:47]
    ds_read_b64_tr_b16 v[74:75], v184 offset:2048
    s_waitcnt lgkmcnt(6)
    v_mfma_f32_16x16x32_bf16 v[48:51], v[84:87], v[120:123], v[48:51]
    ds_read_b64_tr_b16 v[76:77], v185 offset:0
    v_mfma_f32_16x16x32_bf16 v[52:55], v[84:87], v[124:127], v[52:55]
    ds_read_b64_tr_b16 v[78:79], v185 offset:2048
    s_waitcnt lgkmcnt(6)
    v_mfma_f32_16x16x32_bf16 v[56:59], v[88:91], v[120:123], v[56:59]
    ds_read_b64_tr_b16 v[80:81], v186 offset:0
    v_mfma_f32_16x16x32_bf16 v[60:63], v[88:91], v[124:127], v[60:63]
    ds_read_b64_tr_b16 v[82:83], v186 offset:2048
    s_waitcnt lgkmcnt(6)
    v_mfma_f32_16x16x32_bf16 v[64:67], v[92:95], v[120:123], v[64:67]
    ds_read_b64_tr_b16 v[84:85], v187 offset:0
    v_mfma_f32_16x16x32_bf16 v[68:71], v[92:95], v[124:127], v[68:71]
    ds_read_b64_tr_b16 v[86:87], v187 offset:2048
    s_waitcnt lgkmcnt(6)
    v_mfma_f32_16x16x32_bf16 v[0:3], v[72:75], v[128:131], v[0:3]
    ds_read_b64_tr_b16 v[88:89], v188 offset:0
    v_mfma_f32_16x16x32_bf16 v[4:7], v[72:75], v[132:135], v[4:7]
    ds_read_b64_tr_b16 v[90:91], v188 offset:2048
    s_waitcnt lgkmcnt(6)
    v_mfma_f32_16x16x32_bf16 v[8:11], v[76:79], v[128:131], v[8:11]
    ds_read_b64_tr_b16 v[92:93], v189 offset:0
    v_mfma_f32_16x16x32_bf16 v[12:15], v[76:79], v[132:135], v[12:15]
    ds_read_b64_tr_b16 v[94:95], v189 offset:2048
    s_waitcnt lgkmcnt(6)
    v_mfma_f32_16x16x32_bf16 v[16:19], v[80:83], v[128:131], v[16:19]
    ds_read_b64_tr_b16 v[72:73], v190 offset:0
    v_mfma_f32_16x16x32_bf16 v[20:23], v[80:83], v[132:135], v[20:23]
    ds_read_b64_tr_b16 v[74:75], v190 offset:2048
    s_waitcnt lgkmcnt(6)
    v_mfma_f32_16x16x32_bf16 v[24:27], v[84:87], v[128:131], v[24:27]
    ds_read_b64_tr_b16 v[76:77], v191 offset:0
    v_mfma_f32_16x16x32_bf16 v[28:31], v[84:87], v[132:135], v[28:31]
    ds_read_b64_tr_b16 v[78:79], v191 offset:2048
    s_waitcnt lgkmcnt(6)
    v_mfma_f32_16x16x32_bf16 v[32:35], v[88:91], v[128:131], v[32:35]
    ds_read_b64_tr_b16 v[80:81], v193 offset:0
    v_mfma_f32_16x16x32_bf16 v[36:39], v[88:91], v[132:135], v[36:39]
    ds_read_b64_tr_b16 v[82:83], v193 offset:256
    s_waitcnt lgkmcnt(6)
    v_mfma_f32_16x16x32_bf16 v[40:43], v[92:95], v[128:131], v[40:43]
    ds_read_b64_tr_b16 v[84:85], v184 offset:8192
    v_mfma_f32_16x16x32_bf16 v[44:47], v[92:95], v[132:135], v[44:47]
    ds_read_b64_tr_b16 v[86:87], v184 offset:10240
    s_waitcnt lgkmcnt(6)
    v_mfma_f32_16x16x32_bf16 v[48:51], v[72:75], v[128:131], v[48:51]
    ds_read_b64_tr_b16 v[88:89], v185 offset:8192
    v_mfma_f32_16x16x32_bf16 v[52:55], v[72:75], v[132:135], v[52:55]
    ds_read_b64_tr_b16 v[90:91], v185 offset:10240
    s_waitcnt lgkmcnt(6)
    v_mfma_f32_16x16x32_bf16 v[56:59], v[76:79], v[128:131], v[56:59]
    ds_read_b64_tr_b16 v[92:93], v186 offset:8192
    v_mfma_f32_16x16x32_bf16 v[60:63], v[76:79], v[132:135], v[60:63]
    ds_read_b64_tr_b16 v[94:95], v186 offset:10240
    s_waitcnt lgkmcnt(6)
    v_mfma_f32_16x16x32_bf16 v[64:67], v[80:83], v[128:131], v[64:67]
    ds_read_b64_tr_b16 v[72:73], v187 offset:8192
    v_mfma_f32_16x16x32_bf16 v[68:71], v[80:83], v[132:135], v[68:71]
    ds_read_b64_tr_b16 v[74:75], v187 offset:10240
    s_waitcnt lgkmcnt(6)
    v_mfma_f32_16x16x32_bf16 v[0:3], v[84:87], v[136:139], v[0:3]
    ds_read_b64_tr_b16 v[76:77], v188 offset:8192
    v_mfma_f32_16x16x32_bf16 v[4:7], v[84:87], v[140:143], v[4:7]
    ds_read_b64_tr_b16 v[78:79], v188 offset:10240
    s_waitcnt lgkmcnt(6)
    v_mfma_f32_16x16x32_bf16 v[8:11], v[88:91], v[136:139], v[8:11]
    ds_read_b64_tr_b16 v[80:81], v189 offset:8192
    v_mfma_f32_16x16x32_bf16 v[12:15], v[88:91], v[140:143], v[12:15]
    ds_read_b64_tr_b16 v[82:83], v189 offset:10240
    s_waitcnt lgkmcnt(6)
    v_mfma_f32_16x16x32_bf16 v[16:19], v[92:95], v[136:139], v[16:19]
    ds_read_b64_tr_b16 v[84:85], v190 offset:8192
    v_mfma_f32_16x16x32_bf16 v[20:23], v[92:95], v[140:143], v[20:23]
    ds_read_b64_tr_b16 v[86:87], v190 offset:10240
    s_waitcnt lgkmcnt(6)
    v_mfma_f32_16x16x32_bf16 v[24:27], v[72:75], v[136:139], v[24:27]
    ds_read_b64_tr_b16 v[88:89], v191 offset:8192
    v_mfma_f32_16x16x32_bf16 v[28:31], v[72:75], v[140:143], v[28:31]
    ds_read_b64_tr_b16 v[90:91], v191 offset:10240
    s_waitcnt lgkmcnt(6)
    v_mfma_f32_16x16x32_bf16 v[32:35], v[76:79], v[136:139], v[32:35]
    ds_read_b64_tr_b16 v[92:93], v193 offset:1024
    v_mfma_f32_16x16x32_bf16 v[36:39], v[76:79], v[140:143], v[36:39]
    ds_read_b64_tr_b16 v[94:95], v193 offset:1280
    s_waitcnt lgkmcnt(6)
    v_mfma_f32_16x16x32_bf16 v[40:43], v[80:83], v[136:139], v[40:43]
    v_mfma_f32_16x16x32_bf16 v[44:47], v[80:83], v[140:143], v[44:47]
    s_waitcnt lgkmcnt(4)
    v_mfma_f32_16x16x32_bf16 v[48:51], v[84:87], v[136:139], v[48:51]
    v_mfma_f32_16x16x32_bf16 v[52:55], v[84:87], v[140:143], v[52:55]
    s_waitcnt lgkmcnt(2)
    v_mfma_f32_16x16x32_bf16 v[56:59], v[88:91], v[136:139], v[56:59]
    v_mfma_f32_16x16x32_bf16 v[60:63], v[88:91], v[140:143], v[60:63]
    s_waitcnt lgkmcnt(0)
    v_mfma_f32_16x16x32_bf16 v[64:67], v[92:95], v[136:139], v[64:67]
    v_mfma_f32_16x16x32_bf16 v[68:71], v[92:95], v[140:143], v[68:71]
L_p2_done:
    s_mul_i32 s38, s33, 9216
    v_add_u32 v169, s38, v165
    v_add_u32 v168, 110592, v169
    s_lshl_b32 s40, s28, 2
    s_add_u32 s40, s40, s30
    s_lshl_b32 s40, s40, 2
    s_add_u32 s40, s40, s33
    s_lshl_b32 s40, s40, 1
    s_add_u32 s40, s40, s34
    s_mul_i32 s40, s40, 24576
    s_add_u32 s53, s40, 33554432
    s_cmp_lg_u32 s34, 0
    s_cbranch_scc1 L_rsB
    ds_write_b128 v168, v[36:39] offset:0
    ds_write_b128 v168, v[40:43] offset:1024
    ds_write_b128 v168, v[44:47] offset:2048
    ds_write_b128 v168, v[48:51] offset:3072
    ds_write_b128 v168, v[52:55] offset:4096
    ds_write_b128 v168, v[56:59] offset:5120
    ds_write_b128 v168, v[60:63] offset:6144
    ds_write_b128 v168, v[64:67] offset:7168
    ds_write_b128 v168, v[68:71] offset:8192
    s_waitcnt lgkmcnt(0)
    s_barrier
    ds_read_b128 v[72:75], v169 offset:0
    ds_read_b128 v[76:79], v169 offset:1024
    ds_read_b128 v[80:83], v169 offset:2048
    ds_read_b128 v[84:87], v169 offset:3072
    ds_read_b128 v[88:91], v169 offset:4096
    ds_read_b128 v[92:95], v169 offset:5120
    ds_read_b128 v[96:99], v169 offset:6144
    ds_read_b128 v[100:103], v169 offset:7168
    ds_read_b128 v[104:107], v169 offset:8192
    v_mov_b32 v179, s35
    v_mov_b32 v183, s35
    v_mov_b32 v187, s35
    v_mov_b32 v191, s35
    v_mov_b32 v195, s35
    v_mov_b32 v199, s35
    s_waitcnt lgkmcnt(8)
    v_add_f32 v0, v0, v72
    v_add_f32 v1, v1, v73
    v_add_f32 v2, v2, v74
    v_add_f32 v3, v3, v75
    s_waitcnt lgkmcnt(7)
    v_add_f32 v4, v4, v76
    v_add_f32 v5, v5, v77
    v_add_f32 v6, v6, v78
    v_add_f32 v7, v7, v79
    s_waitcnt lgkmcnt(6)
    v_add_f32 v8, v8, v80
    v_add_f32 v9, v9, v81
    v_add_f32 v10, v10, v82
    v_add_f32 v11, v11, v83
    s_waitcnt lgkmcnt(5)
    v_add_f32 v12, v12, v84
    v_add_f32 v13, v13, v85
    v_add_f32 v14, v14, v86
    v_add_f32 v15, v15, v87
    s_waitcnt lgkmcnt(4)
    v_add_f32 v16, v16, v88
    v_add_f32 v17, v17, v89
    v_add_f32 v18, v18, v90
    v_add_f32 v19, v19, v91
    s_waitcnt lgkmcnt(3)
    v_add_f32 v20, v20, v92
    v_add_f32 v21, v21, v93
    v_add_f32 v22, v22, v94
    v_add_f32 v23, v23, v95
    s_waitcnt lgkmcnt(2)
    v_add_f32 v24, v24, v96
    v_add_f32 v25, v25, v97
    v_add_f32 v26, v26, v98
    v_add_f32 v27, v27, v99
    s_waitcnt lgkmcnt(1)
    v_add_f32 v28, v28, v100
    v_add_f32 v29, v29, v101
    v_add_f32 v30, v30, v102
    v_add_f32 v31, v31, v103
    s_waitcnt lgkmcnt(0)
    v_add_f32 v32, v32, v104
    v_add_f32 v33, v33, v105
    v_add_f32 v34, v34, v106
    v_add_f32 v35, v35, v107
    s_cmp_eq_u32 s33, s29
    s_cbranch_scc1 L_rs_own_A
    s_mul_i32 s38, s29, 6144
    s_add_u32 s38, s38, s53
    s_add_u32 s39, s38, 4096
    v_cvt_pk_bf16_f32 v176, v0, v1
    v_cvt_pk_bf16_f32 v177, v2, v3
    v_cvt_pk_bf16_f32 v178, v4, v5
    buffer_store_dwordx4 v[176:179], v165, s[20:23], s38 offen offset:0 sc1
    v_cvt_pk_bf16_f32 v180, v6, v7
    v_cvt_pk_bf16_f32 v181, v8, v9
    v_cvt_pk_bf16_f32 v182, v10, v11
    buffer_store_dwordx4 v[180:183], v165, s[20:23], s38 offen offset:1024 sc1
    v_cvt_pk_bf16_f32 v184, v12, v13
    v_cvt_pk_bf16_f32 v185, v14, v15
    v_cvt_pk_bf16_f32 v186, v16, v17
    buffer_store_dwordx4 v[184:187], v165, s[20:23], s38 offen offset:2048 sc1
    v_cvt_pk_bf16_f32 v188, v18, v19
    v_cvt_pk_bf16_f32 v189, v20, v21
    v_cvt_pk_bf16_f32 v190, v22, v23
    buffer_store_dwordx4 v[188:191], v165, s[20:23], s38 offen offset:3072 sc1
    v_cvt_pk_bf16_f32 v192, v24, v25
    v_cvt_pk_bf16_f32 v193, v26, v27
    v_cvt_pk_bf16_f32 v194, v28, v29
    buffer_store_dwordx4 v[192:195], v165, s[20:23], s39 offen offset:0 sc1
    v_cvt_pk_bf16_f32 v196, v30, v31
    v_cvt_pk_bf16_f32 v197, v32, v33
    v_cvt_pk_bf16_f32 v198, v34, v35
    buffer_store_dwordx4 v[196:199], v165, s[20:23], s39 offen offset:1024 sc1
    s_branch L_end
L_rs_own_A:
    v_and_b32 v170, 15, v243
    v_mul_u32_u24 v170, 1152, v170
    v_lshrrev_b32 v171, 4, v243
    v_lshl_add_u32 v170, v171, 3, v170
    s_mul_i32 s42, s33, 36864
    s_add_u32 s42, s42, s37
    s_lshl_b32 s43, s30, 5
    s_add_u32 s62, s42, s43
    s_add_u32 s62, s62, 1024
    s_add_u32 s63, s62, 18432
    s_lshl_b32 s43, s30, 8
    s_add_u32 s42, s42, s43
    s_add_u32 s43, s42, 18432
    s_add_u32 s38, s29, 1
    s_and_b32 s38, s38, 3
    s_mul_i32 s38, s38, 6144
    s_add_u32 s94, s38, s53
    s_add_u32 s38, s29, 2
    s_and_b32 s38, s38, 3
    s_mul_i32 s38, s38, 6144
    s_add_u32 s95, s38, s53
    s_add_u32 s38, s29, 3
    s_and_b32 s38, s38, 3
    s_mul_i32 s38, s38, 6144
    s_add_u32 s96, s38, s53
    v_mov_b32 v172, 6140
    s_mov_b32 s61, 0
L_rs_poll_A:
    buffer_load_dword v72, v172, s[20:23], s94 offen sc1
    buffer_load_dword v73, v172, s[20:23], s95 offen sc1
    buffer_load_dword v74, v172, s[20:23], s96 offen sc1
    s_add_u32 s61, s61, 1
    s_cmp_gt_u32 s61, 200000
    s_cbranch_scc1 L_rs_spin_A
    s_mov_b64 s[40:41], 0
    s_waitcnt vmcnt(0)
    v_cmp_ne_u32 vcc, s35, v72
    s_or_b64 s[40:41], s[40:41], vcc
    v_cmp_ne_u32 vcc, s35, v73
    s_or_b64 s[40:41], s[40:41], vcc
    v_cmp_ne_u32 vcc, s35, v74
    s_or_b64 s[40:41], s[40:41], vcc
    s_cbranch_scc1 L_rs_poll_A
L_rs_spin_A:
    s_add_u32 s39, s94, 4096
    buffer_load_dwordx4 v[72:75], v165, s[20:23], s94 offen offset:0 sc1
    buffer_load_dwordx4 v[76:79], v165, s[20:23], s94 offen offset:1024 sc1
    buffer_load_dwordx4 v[80:83], v165, s[20:23], s94 offen offset:2048 sc1
    buffer_load_dwordx4 v[84:87], v165, s[20:23], s94 offen offset:3072 sc1
    buffer_load_dwordx4 v[88:91], v165, s[20:23], s39 offen offset:0 sc1
    buffer_load_dwordx4 v[92:95], v165, s[20:23], s39 offen offset:1024 sc1
    s_add_u32 s39, s95, 4096
    buffer_load_dwordx4 v[96:99], v165, s[20:23], s95 offen offset:0 sc1
    buffer_load_dwordx4 v[100:103], v165, s[20:23], s95 offen offset:1024 sc1
    buffer_load_dwordx4 v[104:107], v165, s[20:23], s95 offen offset:2048 sc1
    buffer_load_dwordx4 v[108:111], v165, s[20:23], s95 offen offset:3072 sc1
    buffer_load_dwordx4 v[112:115], v165, s[20:23], s39 offen offset:0 sc1
    buffer_load_dwordx4 v[116:119], v165, s[20:23], s39 offen offset:1024 sc1
    s_add_u32 s39, s96, 4096
    buffer_load_dwordx4 v[120:123], v165, s[20:23], s96 offen offset:0 sc1
    buffer_load_dwordx4 v[124:127], v165, s[20:23], s96 offen offset:1024 sc1
    buffer_load_dwordx4 v[128:131], v165, s[20:23], s96 offen offset:2048 sc1
    buffer_load_dwordx4 v[132:135], v165, s[20:23], s96 offen offset:3072 sc1
    buffer_load_dwordx4 v[136:139], v165, s[20:23], s39 offen offset:0 sc1
    buffer_load_dwordx4 v[140:143], v165, s[20:23], s39 offen offset:1024 sc1
    s_add_u32 s61, s61, 1
    s_cmp_gt_u32 s61, 200000
    s_cbranch_scc1 L_rs_spin_out_A
    s_mov_b64 s[40:41], 0
    s_waitcnt vmcnt(17)
    v_cmp_ne_u32 vcc, s35, v75
    v_lshlrev_b32 v196, 16, v72
    v_and_b32 v197, 0xffff0000, v72
    v_lshlrev_b32 v198, 16, v73
    v_and_b32 v199, 0xffff0000, v73
    v_lshlrev_b32 v200, 16, v74
    v_and_b32 v201, 0xffff0000, v74
    s_or_b64 s[40:41], s[40:41], vcc
    s_waitcnt vmcnt(16)
    v_cmp_ne_u32 vcc, s35, v79
    v_lshlrev_b32 v202, 16, v76
    v_and_b32 v203, 0xffff0000, v76
    v_lshlrev_b32 v204, 16, v77
    v_and_b32 v205, 0xffff0000, v77
    v_lshlrev_b32 v206, 16, v78
    v_and_b32 v207, 0xffff0000, v78
    s_or_b64 s[40:41], s[40:41], vcc
    s_waitcnt vmcnt(15)
    v_cmp_ne_u32 vcc, s35, v83
    v_lshlrev_b32 v208, 16, v80
    v_and_b32 v209, 0xffff0000, v80
    v_lshlrev_b32 v210, 16, v81
    v_and_b32 v211, 0xffff0000, v81
    v_lshlrev_b32 v212, 16, v82
    v_and_b32 v213, 0xffff0000, v82
    s_or_b64 s[40:41], s[40:41], vcc
    s_waitcnt vmcnt(14)
    v_cmp_ne_u32 vcc, s35, v87
    v_lshlrev_b32 v214, 16, v84
    v_and_b32 v215, 0xffff0000, v84
    v_lshlrev_b32 v216, 16, v85
    v_and_b32 v217, 0xffff0000, v85
    v_lshlrev_b32 v218, 16, v86
    v_and_b32 v219, 0xffff0000, v86
    s_or_b64 s[40:41], s[40:41], vcc
    s_waitcnt vmcnt(13)
    v_cmp_ne_u32 vcc, s35, v91
    v_lshlrev_b32 v220, 16, v88
    v_and_b32 v221, 0xffff0000, v88
    v_lshlrev_b32 v222, 16, v89
    v_and_b32 v223, 0xffff0000, v89
    v_lshlrev_b32 v224, 16, v90
    v_and_b32 v225, 0xffff0000, v90
    s_or_b64 s[40:41], s[40:41], vcc
    s_waitcnt vmcnt(12)
    v_cmp_ne_u32 vcc, s35, v95
    v_lshlrev_b32 v226, 16, v92
    v_and_b32 v227, 0xffff0000, v92
    v_lshlrev_b32 v228, 16, v93
    v_and_b32 v229, 0xffff0000, v93
    v_lshlrev_b32 v230, 16, v94
    v_and_b32 v231, 0xffff0000, v94
    s_or_b64 s[40:41], s[40:41], vcc
    s_waitcnt vmcnt(11)
    v_cmp_ne_u32 vcc, s35, v99
    v_lshlrev_b32 v172, 16, v96
    v_and_b32 v173, 0xffff0000, v96
    v_add_f32 v196, v196, v172
    v_add_f32 v197, v197, v173
    v_lshlrev_b32 v172, 16, v97
    v_and_b32 v173, 0xffff0000, v97
    v_add_f32 v198, v198, v172
    v_add_f32 v199, v199, v173
    v_lshlrev_b32 v172, 16, v98
    v_and_b32 v173, 0xffff0000, v98
    v_add_f32 v200, v200, v172
    v_add_f32 v201, v201, v173
    s_or_b64 s[40:41], s[40:41], vcc
    s_waitcnt vmcnt(10)
    v_cmp_ne_u32 vcc, s35, v103
    v_lshlrev_b32 v172, 16, v100
    v_and_b32 v173, 0xffff0000, v100
    v_add_f32 v202, v202, v172
    v_add_f32 v203, v203, v173
    v_lshlrev_b32 v172, 16, v101
    v_and_b32 v173, 0xffff0000, v101
    v_add_f32 v204, v204, v172
    v_add_f32 v205, v205, v173
    v_lshlrev_b32 v172, 16, v102
    v_and_b32 v173, 0xffff0000, v102
    v_add_f32 v206, v206, v172
    v_add_f32 v207, v207, v173
    s_or_b64 s[40:41], s[40:41], vcc
    s_waitcnt vmcnt(9)
    v_cmp_ne_u32 vcc, s35, v107
    v_lshlrev_b32 v172, 16, v104
    v_and_b32 v173, 0xffff0000, v104
    v_add_f32 v208, v208, v172
    v_add_f32 v209, v209, v173
    v_lshlrev_b32 v172, 16, v105
    v_and_b32 v173, 0xffff0000, v105
    v_add_f32 v210, v210, v172
    v_add_f32 v211, v211, v173
    v_lshlrev_b32 v172, 16, v106
    v_and_b32 v173, 0xffff0000, v106
    v_add_f32 v212, v212, v172
    v_add_f32 v213, v213, v173
    s_or_b64 s[40:41], s[40:41], vcc
    s_waitcnt vmcnt(8)
    v_cmp_ne_u32 vcc, s35, v111
    v_lshlrev_b32 v172, 16, v108
    v_and_b32 v173, 0xffff0000, v108
    v_add_f32 v214, v214, v172
    v_add_f32 v215, v215, v173
    v_lshlrev_b32 v172, 16, v109
    v_and_b32 v173, 0xffff0000, v109
    v_add_f32 v216, v216, v172
    v_add_f32 v217, v217, v173
    v_lshlrev_b32 v172, 16, v110
    v_and_b32 v173, 0xffff0000, v110
    v_add_f32 v218, v218, v172
    v_add_f32 v219, v219, v173
    s_or_b64 s[40:41], s[40:41], vcc
    s_waitcnt vmcnt(7)
    v_cmp_ne_u32 vcc, s35, v115
    v_lshlrev_b32 v172, 16, v112
    v_and_b32 v173, 0xffff0000, v112
    v_add_f32 v220, v220, v172
    v_add_f32 v221, v221, v173
    v_lshlrev_b32 v172, 16, v113
    v_and_b32 v173, 0xffff0000, v113
    v_add_f32 v222, v222, v172
    v_add_f32 v223, v223, v173
    v_lshlrev_b32 v172, 16, v114
    v_and_b32 v173, 0xffff0000, v114
    v_add_f32 v224, v224, v172
    v_add_f32 v225, v225, v173
    s_or_b64 s[40:41], s[40:41], vcc
    s_waitcnt vmcnt(6)
    v_cmp_ne_u32 vcc, s35, v119
    v_lshlrev_b32 v172, 16, v116
    v_and_b32 v173, 0xffff0000, v116
    v_add_f32 v226, v226, v172
    v_add_f32 v227, v227, v173
    v_lshlrev_b32 v172, 16, v117
    v_and_b32 v173, 0xffff0000, v117
    v_add_f32 v228, v228, v172
    v_add_f32 v229, v229, v173
    v_lshlrev_b32 v172, 16, v118
    v_and_b32 v173, 0xffff0000, v118
    v_add_f32 v230, v230, v172
    v_add_f32 v231, v231, v173
    s_or_b64 s[40:41], s[40:41], vcc
    s_waitcnt vmcnt(5)
    v_cmp_ne_u32 vcc, s35, v123
    v_lshlrev_b32 v172, 16, v120
    v_and_b32 v173, 0xffff0000, v120
    v_add_f32 v196, v196, v172
    v_add_f32 v197, v197, v173
    v_lshlrev_b32 v172, 16, v121
    v_and_b32 v173, 0xffff0000, v121
    v_add_f32 v198, v198, v172
    v_add_f32 v199, v199, v173
    v_lshlrev_b32 v172, 16, v122
    v_and_b32 v173, 0xffff0000, v122
    v_add_f32 v200, v200, v172
    v_add_f32 v201, v201, v173
    s_or_b64 s[40:41], s[40:41], vcc
    s_waitcnt vmcnt(4)
    v_cmp_ne_u32 vcc, s35, v127
    v_lshlrev_b32 v172, 16, v124
    v_and_b32 v173, 0xffff0000, v124
    v_add_f32 v202, v202, v172
    v_add_f32 v203, v203, v173
    v_lshlrev_b32 v172, 16, v125
    v_and_b32 v173, 0xffff0000, v125
    v_add_f32 v204, v204, v172
    v_add_f32 v205, v205, v173
    v_lshlrev_b32 v172, 16, v126
    v_and_b32 v173, 0xffff0000, v126
    v_add_f32 v206, v206, v172
    v_add_f32 v207, v207, v173
    s_or_b64 s[40:41], s[40:41], vcc
    s_waitcnt vmcnt(3)
    v_cmp_ne_u32 vcc, s35, v131
    v_lshlrev_b32 v172, 16, v128
    v_and_b32 v173, 0xffff0000, v128
    v_add_f32 v208, v208, v172
    v_add_f32 v209, v209, v173
    v_lshlrev_b32 v172, 16, v129
    v_and_b32 v173, 0xffff0000, v129
    v_add_f32 v210, v210, v172
    v_add_f32 v211, v211, v173
    v_lshlrev_b32 v172, 16, v130
    v_and_b32 v173, 0xffff0000, v130
    v_add_f32 v212, v212, v172
    v_add_f32 v213, v213, v173
    s_or_b64 s[40:41], s[40:41], vcc
    s_waitcnt vmcnt(2)
    v_cmp_ne_u32 vcc, s35, v135
    v_lshlrev_b32 v172, 16, v132
    v_and_b32 v173, 0xffff0000, v132
    v_add_f32 v214, v214, v172
    v_add_f32 v215, v215, v173
    v_lshlrev_b32 v172, 16, v133
    v_and_b32 v173, 0xffff0000, v133
    v_add_f32 v216, v216, v172
    v_add_f32 v217, v217, v173
    v_lshlrev_b32 v172, 16, v134
    v_and_b32 v173, 0xffff0000, v134
    v_add_f32 v218, v218, v172
    v_add_f32 v219, v219, v173
    s_or_b64 s[40:41], s[40:41], vcc
    s_waitcnt vmcnt(1)
    v_cmp_ne_u32 vcc, s35, v139
    v_lshlrev_b32 v172, 16, v136
    v_and_b32 v173, 0xffff0000, v136
    v_add_f32 v220, v220, v172
    v_add_f32 v221, v221, v173
    v_lshlrev_b32 v172, 16, v137
    v_and_b32 v173, 0xffff0000, v137
    v_add_f32 v222, v222, v172
    v_add_f32 v223, v223, v173
    v_lshlrev_b32 v172, 16, v138
    v_and_b32 v173, 0xffff0000, v138
    v_add_f32 v224, v224, v172
    v_add_f32 v225, v225, v173
    s_or_b64 s[40:41], s[40:41], vcc
    s_waitcnt vmcnt(0)
    v_cmp_ne_u32 vcc, s35, v143
    v_lshlrev_b32 v172, 16, v140
    v_and_b32 v173, 0xffff0000, v140
    v_add_f32 v226, v226, v172
    v_add_f32 v227, v227, v173
    v_lshlrev_b32 v172, 16, v141
    v_and_b32 v173, 0xffff0000, v141
    v_add_f32 v228, v228, v172
    v_add_f32 v229, v229, v173
    v_lshlrev_b32 v172, 16, v142
    v_and_b32 v173, 0xffff0000, v142
    v_add_f32 v230, v230, v172
    v_add_f32 v231, v231, v173
    s_or_b64 s[40:41], s[40:41], vcc
    s_cbranch_scc1 L_rs_spin_A
L_rs_spin_out_A:
    s_waitcnt vmcnt(0)
    v_add_f32 v0, v0, v196
    v_add_f32 v1, v1, v197
    v_add_f32 v2, v2, v198
    v_add_f32 v3, v3, v199
    v_add_f32 v4, v4, v200
    v_add_f32 v5, v5, v201
    v_add_f32 v6, v6, v202
    v_add_f32 v7, v7, v203
    v_add_f32 v8, v8, v204
    v_add_f32 v9, v9, v205
    v_add_f32 v10, v10, v206
    v_add_f32 v11, v11, v207
    v_add_f32 v12, v12, v208
    v_add_f32 v13, v13, v209
    v_add_f32 v14, v14, v210
    v_add_f32 v15, v15, v211
    v_add_f32 v16, v16, v212
    v_add_f32 v17, v17, v213
    v_add_f32 v18, v18, v214
    v_add_f32 v19, v19, v215
    v_add_f32 v20, v20, v216
    v_add_f32 v21, v21, v217
    v_add_f32 v22, v22, v218
    v_add_f32 v23, v23, v219
    v_add_f32 v24, v24, v220
    v_add_f32 v25, v25, v221
    v_add_f32 v26, v26, v222
    v_add_f32 v27, v27, v223
    v_add_f32 v28, v28, v224
    v_add_f32 v29, v29, v225
    v_add_f32 v30, v30, v226
    v_add_f32 v31, v31, v227
    v_add_f32 v32, v32, v228
    v_add_f32 v33, v33, v229
    v_add_f32 v34, v34, v230
    v_add_f32 v35, v35, v231
    v_cvt_pk_bf16_f32 v176, v0, v1
    v_cvt_pk_bf16_f32 v177, v2, v3
    buffer_store_dwordx2 v[176:177], v170, s[16:19], s42 offen offset:0
    v_cvt_pk_bf16_f32 v178, v4, v5
    v_cvt_pk_bf16_f32 v179, v6, v7
    buffer_store_dwordx2 v[178:179], v170, s[16:19], s43 offen offset:0
    v_cvt_pk_bf16_f32 v180, v8, v9
    v_cvt_pk_bf16_f32 v181, v10, v11
    buffer_store_dwordx2 v[180:181], v170, s[16:19], s42 offen offset:32
    v_cvt_pk_bf16_f32 v182, v12, v13
    v_cvt_pk_bf16_f32 v183, v14, v15
    buffer_store_dwordx2 v[182:183], v170, s[16:19], s43 offen offset:32
    v_cvt_pk_bf16_f32 v184, v16, v17
    v_cvt_pk_bf16_f32 v185, v18, v19
    buffer_store_dwordx2 v[184:185], v170, s[16:19], s42 offen offset:64
    v_cvt_pk_bf16_f32 v186, v20, v21
    v_cvt_pk_bf16_f32 v187, v22, v23
    buffer_store_dwordx2 v[186:187], v170, s[16:19], s43 offen offset:64
    v_cvt_pk_bf16_f32 v188, v24, v25
    v_cvt_pk_bf16_f32 v189, v26, v27
    buffer_store_dwordx2 v[188:189], v170, s[16:19], s42 offen offset:96
    v_cvt_pk_bf16_f32 v190, v28, v29
    v_cvt_pk_bf16_f32 v191, v30, v31
    buffer_store_dwordx2 v[190:191], v170, s[16:19], s43 offen offset:96
    v_cvt_pk_bf16_f32 v176, v32, v33
    v_cvt_pk_bf16_f32 v177, v34, v35
    buffer_store_dwordx2 v[176:177], v170, s[16:19], s42 offen offset:128
    s_branch L_end
L_rsB:
    ds_write_b128 v169, v[0:3] offset:0
    ds_write_b128 v169, v[4:7] offset:1024
    ds_write_b128 v169, v[8:11] offset:2048
    ds_write_b128 v169, v[12:15] offset:3072
    ds_write_b128 v169, v[16:19] offset:4096
    ds_write_b128 v169, v[20:23] offset:5120
    ds_write_b128 v169, v[24:27] offset:6144
    ds_write_b128 v169, v[28:31] offset:7168
    ds_write_b128 v169, v[32:35] offset:8192
    s_waitcnt lgkmcnt(0)
    s_barrier
    ds_read_b128 v[72:75], v168 offset:0
    ds_read_b128 v[76:79], v168 offset:1024
    ds_read_b128 v[80:83], v168 offset:2048
    ds_read_b128 v[84:87], v168 offset:3072
    ds_read_b128 v[88:91], v168 offset:4096
    ds_read_b128 v[92:95], v168 offset:5120
    ds_read_b128 v[96:99], v168 offset:6144
    ds_read_b128 v[100:103], v168 offset:7168
    ds_read_b128 v[104:107], v168 offset:8192
    v_mov_b32 v179, s35
    v_mov_b32 v183, s35
    v_mov_b32 v187, s35
    v_mov_b32 v191, s35
    v_mov_b32 v195, s35
    v_mov_b32 v199, s35
    s_waitcnt lgkmcnt(8)
    v_add_f32 v36, v36, v72
    v_add_f32 v37, v37, v73
    v_add_f32 v38, v38, v74
    v_add_f32 v39, v39, v75
    s_waitcnt lgkmcnt(7)
    v_add_f32 v40, v40, v76
    v_add_f32 v41, v41, v77
    v_add_f32 v42, v42, v78
    v_add_f32 v43, v43, v79
    s_waitcnt lgkmcnt(6)
    v_add_f32 v44, v44, v80
    v_add_f32 v45, v45, v81
    v_add_f32 v46, v46, v82
    v_add_f32 v47, v47, v83
    s_waitcnt lgkmcnt(5)
    v_add_f32 v48, v48, v84
    v_add_f32 v49, v49, v85
    v_add_f32 v50, v50, v86
    v_add_f32 v51, v51, v87
    s_waitcnt lgkmcnt(4)
    v_add_f32 v52, v52, v88
    v_add_f32 v53, v53, v89
    v_add_f32 v54, v54, v90
    v_add_f32 v55, v55, v91
    s_waitcnt lgkmcnt(3)
    v_add_f32 v56, v56, v92
    v_add_f32 v57, v57, v93
    v_add_f32 v58, v58, v94
    v_add_f32 v59, v59, v95
    s_waitcnt lgkmcnt(2)
    v_add_f32 v60, v60, v96
    v_add_f32 v61, v61, v97
    v_add_f32 v62, v62, v98
    v_add_f32 v63, v63, v99
    s_waitcnt lgkmcnt(1)
    v_add_f32 v64, v64, v100
    v_add_f32 v65, v65, v101
    v_add_f32 v66, v66, v102
    v_add_f32 v67, v67, v103
    s_waitcnt lgkmcnt(0)
    v_add_f32 v68, v68, v104
    v_add_f32 v69, v69, v105
    v_add_f32 v70, v70, v106
    v_add_f32 v71, v71, v107
    s_cmp_eq_u32 s33, s29
    s_cbranch_scc1 L_rs_own_B
    s_mul_i32 s38, s29, 6144
    s_add_u32 s38, s38, s53
    s_add_u32 s39, s38, 4096
    v_cvt_pk_bf16_f32 v176, v36, v37
    v_cvt_pk_bf16_f32 v177, v38, v39
    v_cvt_pk_bf16_f32 v178, v40, v41
    buffer_store_dwordx4 v[176:179], v165, s[20:23], s38 offen offset:0 sc1
    v_cvt_pk_bf16_f32 v180, v42, v43
    v_cvt_pk_bf16_f32 v181, v44, v45
    v_cvt_pk_bf16_f32 v182, v46, v47
    buffer_store_dwordx4 v[180:183], v165, s[20:23], s38 offen offset:1024 sc1
    v_cvt_pk_bf16_f32 v184, v48, v49
    v_cvt_pk_bf16_f32 v185, v50, v51
    v_cvt_pk_bf16_f32 v186, v52, v53
    buffer_store_dwordx4 v[184:187], v165, s[20:23], s38 offen offset:2048 sc1
    v_cvt_pk_bf16_f32 v188, v54, v55
    v_cvt_pk_bf16_f32 v189, v56, v57
    v_cvt_pk_bf16_f32 v190, v58, v59
    buffer_store_dwordx4 v[188:191], v165, s[20:23], s38 offen offset:3072 sc1
    v_cvt_pk_bf16_f32 v192, v60, v61
    v_cvt_pk_bf16_f32 v193, v62, v63
    v_cvt_pk_bf16_f32 v194, v64, v65
    buffer_store_dwordx4 v[192:195], v165, s[20:23], s39 offen offset:0 sc1
    v_cvt_pk_bf16_f32 v196, v66, v67
    v_cvt_pk_bf16_f32 v197, v68, v69
    v_cvt_pk_bf16_f32 v198, v70, v71
    buffer_store_dwordx4 v[196:199], v165, s[20:23], s39 offen offset:1024 sc1
    s_branch L_end
L_rs_own_B:
    v_and_b32 v170, 15, v243
    v_mul_u32_u24 v170, 1152, v170
    v_lshrrev_b32 v171, 4, v243
    v_lshl_add_u32 v170, v171, 3, v170
    s_mul_i32 s42, s33, 36864
    s_add_u32 s42, s42, s37
    s_lshl_b32 s43, s30, 5
    s_add_u32 s62, s42, s43
    s_add_u32 s62, s62, 1024
    s_add_u32 s63, s62, 18432
    s_lshl_b32 s43, s30, 8
    s_add_u32 s42, s42, s43
    s_add_u32 s43, s42, 18432
    s_add_u32 s38, s29, 1
    s_and_b32 s38, s38, 3
    s_mul_i32 s38, s38, 6144
    s_add_u32 s94, s38, s53
    s_add_u32 s38, s29, 2
    s_and_b32 s38, s38, 3
    s_mul_i32 s38, s38, 6144
    s_add_u32 s95, s38, s53
    s_add_u32 s38, s29, 3
    s_and_b32 s38, s38, 3
    s_mul_i32 s38, s38, 6144
    s_add_u32 s96, s38, s53
    v_mov_b32 v172, 6140
    s_mov_b32 s61, 0
L_rs_poll_B:
    buffer_load_dword v72, v172, s[20:23], s94 offen sc1
    buffer_load_dword v73, v172, s[20:23], s95 offen sc1
    buffer_load_dword v74, v172, s[20:23], s96 offen sc1
    s_add_u32 s61, s61, 1
    s_cmp_gt_u32 s61, 200000
    s_cbranch_scc1 L_rs_spin_B
    s_mov_b64 s[40:41], 0
    s_waitcnt vmcnt(0)
    v_cmp_ne_u32 vcc, s35, v72
    s_or_b64 s[40:41], s[40:41], vcc
    v_cmp_ne_u32 vcc, s35, v73
    s_or_b64 s[40:41], s[40:41], vcc
    v_cmp_ne_u32 vcc, s35, v74
    s_or_b64 s[40:41], s[40:41], vcc
    s_cbranch_scc1 L_rs_poll_B
L_rs_spin_B:
    s_add_u32 s39, s94, 4096
    buffer_load_dwordx4 v[72:75], v165, s[20:23], s94 offen offset:0 sc1
    buffer_load_dwordx4 v[76:79], v165, s[20:23], s94 offen offset:1024 sc1
    buffer_load_dwordx4 v[80:83], v165, s[20:23], s94 offen offset:2048 sc1
    buffer_load_dwordx4 v[84:87], v165, s[20:23], s94 offen offset:3072 sc1
    buffer_load_dwordx4 v[88:91], v165, s[20:23], s39 offen offset:0 sc1
    buffer_load_dwordx4 v[92:95], v165, s[20:23], s39 offen offset:1024 sc1
    s_add_u32 s39, s95, 4096
    buffer_load_dwordx4 v[96:99], v165, s[20:23], s95 offen offset:0 sc1
    buffer_load_dwordx4 v[100:103], v165, s[20:23], s95 offen offset:1024 sc1
    buffer_load_dwordx4 v[104:107], v165, s[20:23], s95 offen offset:2048 sc1
    buffer_load_dwordx4 v[108:111], v165, s[20:23], s95 offen offset:3072 sc1
    buffer_load_dwordx4 v[112:115], v165, s[20:23], s39 offen offset:0 sc1
    buffer_load_dwordx4 v[116:119], v165, s[20:23], s39 offen offset:1024 sc1
    s_add_u32 s39, s96, 4096
    buffer_load_dwordx4 v[120:123], v165, s[20:23], s96 offen offset:0 sc1
    buffer_load_dwordx4 v[124:127], v165, s[20:23], s96 offen offset:1024 sc1
    buffer_load_dwordx4 v[128:131], v165, s[20:23], s96 offen offset:2048 sc1
    buffer_load_dwordx4 v[132:135], v165, s[20:23], s96 offen offset:3072 sc1
    buffer_load_dwordx4 v[136:139], v165, s[20:23], s39 offen offset:0 sc1
    buffer_load_dwordx4 v[140:143], v165, s[20:23], s39 offen offset:1024 sc1
    s_add_u32 s61, s61, 1
    s_cmp_gt_u32 s61, 200000
    s_cbranch_scc1 L_rs_spin_out_B
    s_mov_b64 s[40:41], 0
    s_waitcnt vmcnt(17)
    v_cmp_ne_u32 vcc, s35, v75
    v_lshlrev_b32 v196, 16, v72
    v_and_b32 v197, 0xffff0000, v72
    v_lshlrev_b32 v198, 16, v73
    v_and_b32 v199, 0xffff0000, v73
    v_lshlrev_b32 v200, 16, v74
    v_and_b32 v201, 0xffff0000, v74
    s_or_b64 s[40:41], s[40:41], vcc
    s_waitcnt vmcnt(16)
    v_cmp_ne_u32 vcc, s35, v79
    v_lshlrev_b32 v202, 16, v76
    v_and_b32 v203, 0xffff0000, v76
    v_lshlrev_b32 v204, 16, v77
    v_and_b32 v205, 0xffff0000, v77
    v_lshlrev_b32 v206, 16, v78
    v_and_b32 v207, 0xffff0000, v78
    s_or_b64 s[40:41], s[40:41], vcc
    s_waitcnt vmcnt(15)
    v_cmp_ne_u32 vcc, s35, v83
    v_lshlrev_b32 v208, 16, v80
    v_and_b32 v209, 0xffff0000, v80
    v_lshlrev_b32 v210, 16, v81
    v_and_b32 v211, 0xffff0000, v81
    v_lshlrev_b32 v212, 16, v82
    v_and_b32 v213, 0xffff0000, v82
    s_or_b64 s[40:41], s[40:41], vcc
    s_waitcnt vmcnt(14)
    v_cmp_ne_u32 vcc, s35, v87
    v_lshlrev_b32 v214, 16, v84
    v_and_b32 v215, 0xffff0000, v84
    v_lshlrev_b32 v216, 16, v85
    v_and_b32 v217, 0xffff0000, v85
    v_lshlrev_b32 v218, 16, v86
    v_and_b32 v219, 0xffff0000, v86
    s_or_b64 s[40:41], s[40:41], vcc
    s_waitcnt vmcnt(13)
    v_cmp_ne_u32 vcc, s35, v91
    v_lshlrev_b32 v220, 16, v88
    v_and_b32 v221, 0xffff0000, v88
    v_lshlrev_b32 v222, 16, v89
    v_and_b32 v223, 0xffff0000, v89
    v_lshlrev_b32 v224, 16, v90
    v_and_b32 v225, 0xffff0000, v90
    s_or_b64 s[40:41], s[40:41], vcc
    s_waitcnt vmcnt(12)
    v_cmp_ne_u32 vcc, s35, v95
    v_lshlrev_b32 v226, 16, v92
    v_and_b32 v227, 0xffff0000, v92
    v_lshlrev_b32 v228, 16, v93
    v_and_b32 v229, 0xffff0000, v93
    v_lshlrev_b32 v230, 16, v94
    v_and_b32 v231, 0xffff0000, v94
    s_or_b64 s[40:41], s[40:41], vcc
    s_waitcnt vmcnt(11)
    v_cmp_ne_u32 vcc, s35, v99
    v_lshlrev_b32 v172, 16, v96
    v_and_b32 v173, 0xffff0000, v96
    v_add_f32 v196, v196, v172
    v_add_f32 v197, v197, v173
    v_lshlrev_b32 v172, 16, v97
    v_and_b32 v173, 0xffff0000, v97
    v_add_f32 v198, v198, v172
    v_add_f32 v199, v199, v173
    v_lshlrev_b32 v172, 16, v98
    v_and_b32 v173, 0xffff0000, v98
    v_add_f32 v200, v200, v172
    v_add_f32 v201, v201, v173
    s_or_b64 s[40:41], s[40:41], vcc
    s_waitcnt vmcnt(10)
    v_cmp_ne_u32 vcc, s35, v103
    v_lshlrev_b32 v172, 16, v100
    v_and_b32 v173, 0xffff0000, v100
    v_add_f32 v202, v202, v172
    v_add_f32 v203, v203, v173
    v_lshlrev_b32 v172, 16, v101
    v_and_b32 v173, 0xffff0000, v101
    v_add_f32 v204, v204, v172
    v_add_f32 v205, v205, v173
    v_lshlrev_b32 v172, 16, v102
    v_and_b32 v173, 0xffff0000, v102
    v_add_f32 v206, v206, v172
    v_add_f32 v207, v207, v173
    s_or_b64 s[40:41], s[40:41], vcc
    s_waitcnt vmcnt(9)
    v_cmp_ne_u32 vcc, s35, v107
    v_lshlrev_b32 v172, 16, v104
    v_and_b32 v173, 0xffff0000, v104
    v_add_f32 v208, v208, v172
    v_add_f32 v209, v209, v173
    v_lshlrev_b32 v172, 16, v105
    v_and_b32 v173, 0xffff0000, v105
    v_add_f32 v210, v210, v172
    v_add_f32 v211, v211, v173
    v_lshlrev_b32 v172, 16, v106
    v_and_b32 v173, 0xffff0000, v106
    v_add_f32 v212, v212, v172
    v_add_f32 v213, v213, v173
    s_or_b64 s[40:41], s[40:41], vcc
    s_waitcnt vmcnt(8)
    v_cmp_ne_u32 vcc, s35, v111
    v_lshlrev_b32 v172, 16, v108
    v_and_b32 v173, 0xffff0000, v108
    v_add_f32 v214, v214, v172
    v_add_f32 v215, v215, v173
    v_lshlrev_b32 v172, 16, v109
    v_and_b32 v173, 0xffff0000, v109
    v_add_f32 v216, v216, v172
    v_add_f32 v217, v217, v173
    v_lshlrev_b32 v172, 16, v110
    v_and_b32 v173, 0xffff0000, v110
    v_add_f32 v218, v218, v172
    v_add_f32 v219, v219, v173
    s_or_b64 s[40:41], s[40:41], vcc
    s_waitcnt vmcnt(7)
    v_cmp_ne_u32 vcc, s35, v115
    v_lshlrev_b32 v172, 16, v112
    v_and_b32 v173, 0xffff0000, v112
    v_add_f32 v220, v220, v172
    v_add_f32 v221, v221, v173
    v_lshlrev_b32 v172, 16, v113
    v_and_b32 v173, 0xffff0000, v113
    v_add_f32 v222, v222, v172
    v_add_f32 v223, v223, v173
    v_lshlrev_b32 v172, 16, v114
    v_and_b32 v173, 0xffff0000, v114
    v_add_f32 v224, v224, v172
    v_add_f32 v225, v225, v173
    s_or_b64 s[40:41], s[40:41], vcc
    s_waitcnt vmcnt(6)
    v_cmp_ne_u32 vcc, s35, v119
    v_lshlrev_b32 v172, 16, v116
    v_and_b32 v173, 0xffff0000, v116
    v_add_f32 v226, v226, v172
    v_add_f32 v227, v227, v173
    v_lshlrev_b32 v172, 16, v117
    v_and_b32 v173, 0xffff0000, v117
    v_add_f32 v228, v228, v172
    v_add_f32 v229, v229, v173
    v_lshlrev_b32 v172, 16, v118
    v_and_b32 v173, 0xffff0000, v118
    v_add_f32 v230, v230, v172
    v_add_f32 v231, v231, v173
    s_or_b64 s[40:41], s[40:41], vcc
    s_waitcnt vmcnt(5)
    v_cmp_ne_u32 vcc, s35, v123
    v_lshlrev_b32 v172, 16, v120
    v_and_b32 v173, 0xffff0000, v120
    v_add_f32 v196, v196, v172
    v_add_f32 v197, v197, v173
    v_lshlrev_b32 v172, 16, v121
    v_and_b32 v173, 0xffff0000, v121
    v_add_f32 v198, v198, v172
    v_add_f32 v199, v199, v173
    v_lshlrev_b32 v172, 16, v122
    v_and_b32 v173, 0xffff0000, v122
    v_add_f32 v200, v200, v172
    v_add_f32 v201, v201, v173
    s_or_b64 s[40:41], s[40:41], vcc
    s_waitcnt vmcnt(4)
    v_cmp_ne_u32 vcc, s35, v127
    v_lshlrev_b32 v172, 16, v124
    v_and_b32 v173, 0xffff0000, v124
    v_add_f32 v202, v202, v172
    v_add_f32 v203, v203, v173
    v_lshlrev_b32 v172, 16, v125
    v_and_b32 v173, 0xffff0000, v125
    v_add_f32 v204, v204, v172
    v_add_f32 v205, v205, v173
    v_lshlrev_b32 v172, 16, v126
    v_and_b32 v173, 0xffff0000, v126
    v_add_f32 v206, v206, v172
    v_add_f32 v207, v207, v173
    s_or_b64 s[40:41], s[40:41], vcc
    s_waitcnt vmcnt(3)
    v_cmp_ne_u32 vcc, s35, v131
    v_lshlrev_b32 v172, 16, v128
    v_and_b32 v173, 0xffff0000, v128
    v_add_f32 v208, v208, v172
    v_add_f32 v209, v209, v173
    v_lshlrev_b32 v172, 16, v129
    v_and_b32 v173, 0xffff0000, v129
    v_add_f32 v210, v210, v172
    v_add_f32 v211, v211, v173
    v_lshlrev_b32 v172, 16, v130
    v_and_b32 v173, 0xffff0000, v130
    v_add_f32 v212, v212, v172
    v_add_f32 v213, v213, v173
    s_or_b64 s[40:41], s[40:41], vcc
    s_waitcnt vmcnt(2)
    v_cmp_ne_u32 vcc, s35, v135
    v_lshlrev_b32 v172, 16, v132
    v_and_b32 v173, 0xffff0000, v132
    v_add_f32 v214, v214, v172
    v_add_f32 v215, v215, v173
    v_lshlrev_b32 v172, 16, v133
    v_and_b32 v173, 0xffff0000, v133
    v_add_f32 v216, v216, v172
    v_add_f32 v217, v217, v173
    v_lshlrev_b32 v172, 16, v134
    v_and_b32 v173, 0xffff0000, v134
    v_add_f32 v218, v218, v172
    v_add_f32 v219, v219, v173
    s_or_b64 s[40:41], s[40:41], vcc
    s_waitcnt vmcnt(1)
    v_cmp_ne_u32 vcc, s35, v139
    v_lshlrev_b32 v172, 16, v136
    v_and_b32 v173, 0xffff0000, v136
    v_add_f32 v220, v220, v172
    v_add_f32 v221, v221, v173
    v_lshlrev_b32 v172, 16, v137
    v_and_b32 v173, 0xffff0000, v137
    v_add_f32 v222, v222, v172
    v_add_f32 v223, v223, v173
    v_lshlrev_b32 v172, 16, v138
    v_and_b32 v173, 0xffff0000, v138
    v_add_f32 v224, v224, v172
    v_add_f32 v225, v225, v173
    s_or_b64 s[40:41], s[40:41], vcc
    s_waitcnt vmcnt(0)
    v_cmp_ne_u32 vcc, s35, v143
    v_lshlrev_b32 v172, 16, v140
    v_and_b32 v173, 0xffff0000, v140
    v_add_f32 v226, v226, v172
    v_add_f32 v227, v227, v173
    v_lshlrev_b32 v172, 16, v141
    v_and_b32 v173, 0xffff0000, v141
    v_add_f32 v228, v228, v172
    v_add_f32 v229, v229, v173
    v_lshlrev_b32 v172, 16, v142
    v_and_b32 v173, 0xffff0000, v142
    v_add_f32 v230, v230, v172
    v_add_f32 v231, v231, v173
    s_or_b64 s[40:41], s[40:41], vcc
    s_cbranch_scc1 L_rs_spin_B
L_rs_spin_out_B:
    s_waitcnt vmcnt(0)
    v_add_f32 v36, v36, v196
    v_add_f32 v37, v37, v197
    v_add_f32 v38, v38, v198
    v_add_f32 v39, v39, v199
    v_add_f32 v40, v40, v200
    v_add_f32 v41, v41, v201
    v_add_f32 v42, v42, v202
    v_add_f32 v43, v43, v203
    v_add_f32 v44, v44, v204
    v_add_f32 v45, v45, v205
    v_add_f32 v46, v46, v206
    v_add_f32 v47, v47, v207
    v_add_f32 v48, v48, v208
    v_add_f32 v49, v49, v209
    v_add_f32 v50, v50, v210
    v_add_f32 v51, v51, v211
    v_add_f32 v52, v52, v212
    v_add_f32 v53, v53, v213
    v_add_f32 v54, v54, v214
    v_add_f32 v55, v55, v215
    v_add_f32 v56, v56, v216
    v_add_f32 v57, v57, v217
    v_add_f32 v58, v58, v218
    v_add_f32 v59, v59, v219
    v_add_f32 v60, v60, v220
    v_add_f32 v61, v61, v221
    v_add_f32 v62, v62, v222
    v_add_f32 v63, v63, v223
    v_add_f32 v64, v64, v224
    v_add_f32 v65, v65, v225
    v_add_f32 v66, v66, v226
    v_add_f32 v67, v67, v227
    v_add_f32 v68, v68, v228
    v_add_f32 v69, v69, v229
    v_add_f32 v70, v70, v230
    v_add_f32 v71, v71, v231
    v_cvt_pk_bf16_f32 v176, v36, v37
    v_cvt_pk_bf16_f32 v177, v38, v39
    buffer_store_dwordx2 v[176:177], v170, s[16:19], s43 offen offset:128
    v_cvt_pk_bf16_f32 v178, v40, v41
    v_cvt_pk_bf16_f32 v179, v42, v43
    buffer_store_dwordx2 v[178:179], v170, s[16:19], s42 offen offset:160
    v_cvt_pk_bf16_f32 v180, v44, v45
    v_cvt_pk_bf16_f32 v181, v46, v47
    buffer_store_dwordx2 v[180:181], v170, s[16:19], s43 offen offset:160
    v_cvt_pk_bf16_f32 v182, v48, v49
    v_cvt_pk_bf16_f32 v183, v50, v51
    buffer_store_dwordx2 v[182:183], v170, s[16:19], s42 offen offset:192
    v_cvt_pk_bf16_f32 v184, v52, v53
    v_cvt_pk_bf16_f32 v185, v54, v55
    buffer_store_dwordx2 v[184:185], v170, s[16:19], s43 offen offset:192
    v_cvt_pk_bf16_f32 v186, v56, v57
    v_cvt_pk_bf16_f32 v187, v58, v59
    buffer_store_dwordx2 v[186:187], v170, s[16:19], s42 offen offset:224
    v_cvt_pk_bf16_f32 v188, v60, v61
    v_cvt_pk_bf16_f32 v189, v62, v63
    buffer_store_dwordx2 v[188:189], v170, s[16:19], s43 offen offset:224
    v_cvt_pk_bf16_f32 v190, v64, v65
    v_cvt_pk_bf16_f32 v191, v66, v67
    buffer_store_dwordx2 v[190:191], v170, s[16:19], s62 offen
    v_cvt_pk_bf16_f32 v176, v68, v69
    v_cvt_pk_bf16_f32 v177, v70, v71
    buffer_store_dwordx2 v[176:177], v170, s[16:19], s63 offen
    s_branch L_end
L_end:
    s_endpgm
.section .rodata,"a"
.p2align 6
.amdhsa_kernel standalone__dense_activation_silu__prompt_kernel
  .amdhsa_next_free_vgpr 256
  .amdhsa_next_free_sgpr 102
  .amdhsa_accum_offset 256
  .amdhsa_group_segment_fixed_size 0
  .amdhsa_kernarg_size 48
  .amdhsa_user_sgpr_count 2
  .amdhsa_user_sgpr_kernarg_segment_ptr 1
  .amdhsa_system_sgpr_workgroup_id_x 1
.end_amdhsa_kernel
```
